```python
import torch

def _softmax(x, axis=-1):
    return torch.softmax(x, dim=axis)
def _gelu(x):
    return torch.nn.functional.gelu(x, approximate="tanh")
def _silu(x):
    return torch.nn.functional.silu(x)
def _sigmoid(x):
    return torch.sigmoid(x)
def _layernorm(x, axis=-1, eps=1e-5):
    m = x.mean(dim=axis, keepdim=True)
    v = x.var(dim=axis, keepdim=True, unbiased=False)
    return (x - m) / torch.sqrt(v + eps)
def _scatter_add(tgt, idx, src, axis=0):
    return tgt.clone().index_add_(axis, idx, src)
def _segment_sum(src, seg, n):
    out = torch.zeros((n,) + src.shape[1:], dtype=src.dtype)
    return out.index_add_(0, seg, src)
def _pad(x, pw):
    flat = tuple(v for pair in reversed(pw) for v in pair)
    return torch.nn.functional.pad(x, flat)

kernel_name = 'gated_mix__ssm_conv_s5__dense_activation_squared_relu__prompt'

def setup_inputs():

    _w = (lambda a: (lambda t: t.to(torch.bfloat16) if t.is_floating_point() else t)(torch.as_tensor(a)))
    def _A_setup():
        B, S, D = 1, 2048, 512
        P = D
        Lambda_re = -0.5 * (lambda _x: torch.exp(torch.as_tensor(_x)))((lambda *s: torch.randn(*s, dtype=torch.bfloat16) * 0.4)(P))
        Lambda_im = (lambda *s: torch.randn(*s, dtype=torch.bfloat16) * 0.8)(P) * 1.0
        B_re = (lambda *s: torch.randn(*s, dtype=torch.bfloat16) * 0.8)(P, D) * (D ** -0.5)
        B_im = (lambda *s: torch.randn(*s, dtype=torch.bfloat16) * 0.8)(P, D) * (D ** -0.5)
        C_re = (lambda *s: torch.randn(*s, dtype=torch.bfloat16) * 0.8)(D, P) * (P ** -0.5)
        C_im = (lambda *s: torch.randn(*s, dtype=torch.bfloat16) * 0.8)(D, P) * (P ** -0.5)
        log_dt = (lambda *s: torch.randn(*s, dtype=torch.bfloat16) * 0.4)(P) * 0.3 - 2.0
        Dskip = (lambda *s: torch.randn(*s, dtype=torch.bfloat16) * 0.1)(D)
        return {
            "x": _w((lambda *s: torch.randn(*s, dtype=torch.bfloat16) * 0.05)(B, S, D)),
            "Lambda_re": _w(Lambda_re),
            "Lambda_im": _w(Lambda_im),
            "B_re": _w(B_re),
            "B_im": _w(B_im),
            "C_re": _w(C_re),
            "C_im": _w(C_im),
            "log_dt": _w(log_dt),
            "Dskip": _w(Dskip),
        }
    _A_in = _A_setup()

    def _B_setup():
        B, S, D, F = 1, 2048, 512, 1792
        return {
            "x": _w((lambda *s: torch.randn(*s, dtype=torch.bfloat16) * 0.05)(B, S, D)),
            "w1": _w((lambda *s: torch.randn(*s, dtype=torch.bfloat16) * 0.05)(D, F)),
            "b1": _w((lambda *s: torch.randn(*s, dtype=torch.bfloat16) * 0.05)(F)),
            "w2": _w((lambda *s: torch.randn(*s, dtype=torch.bfloat16) * 0.05)(F, D)),
            "b2": _w((lambda *s: torch.randn(*s, dtype=torch.bfloat16) * 0.05)(D)),
        }
    _B_in = _B_setup()

    return {
        "A_x": _A_in["x"],
        "A_Lambda_re": _A_in["Lambda_re"],
        "A_Lambda_im": _A_in["Lambda_im"],
        "A_B_re": _A_in["B_re"],
        "A_B_im": _A_in["B_im"],
        "A_C_re": _A_in["C_re"],
        "A_C_im": _A_in["C_im"],
        "A_log_dt": _A_in["log_dt"],
        "A_Dskip": _A_in["Dskip"],
        "B_x": _B_in["x"],
        "B_w1": _B_in["w1"],
        "B_b1": _B_in["b1"],
        "B_w2": _B_in["w2"],
        "B_b2": _B_in["b2"],
        "gate_w": _w((lambda *s: torch.randn(*s, dtype=torch.bfloat16) * 0.05)(512) * 16.0),
    }

def reference(A_x, A_Lambda_re, A_Lambda_im, A_B_re, A_B_im, A_C_re, A_C_im, A_log_dt, A_Dskip, B_x, B_w1, B_b1, B_w2, B_b2, gate_w):
    def _A_ref(x, Lambda_re, Lambda_im, B_re, B_im, C_re, C_im, log_dt, Dskip):
        Bsz, L, H = x.shape
        Lam = Lambda_re + 1j * Lambda_im
        Bmat = B_re + 1j * B_im
        Cmat = C_re + 1j * C_im
        dt = torch.exp(log_dt)
        Lam_bar = torch.exp(dt * Lam)
        B_bar = ((Lam_bar - 1.0) / Lam)[:, None] * Bmat
        Bu = torch.einsum("bld,pd->blp", x + 0j, B_bar)
        h = torch.zeros_like(Bu[:, 0, :])
        hs = []
        for t in range(L):
            h = Lam_bar[None, :] * h + Bu[:, t, :]
            hs.append(h)
        hseq = torch.stack(hs, 1)
        y = 2.0 * torch.einsum("blp,dp->bld", hseq, Cmat).real + x * Dskip[None, None, :]
        return y

    def _B_ref(x, w1, b1, w2, b2):
        h = torch.einsum("bsd,df->bsf", x, w1) + b1
        zero = torch.zeros_like(h)
        r = torch.where(h > zero, h, zero)
        h = r * r
        out = torch.einsum("bsf,fd->bsd", h, w2) + b2
        return out

    x = A_x
    g = _sigmoid((x * gate_w).sum(-1, keepdims=True))
    a = _A_ref(x, A_Lambda_re, A_Lambda_im, A_B_re, A_B_im, A_C_re, A_C_im, A_log_dt, A_Dskip)
    b = _B_ref(x, B_w1, B_b1, B_w2, B_b2)
    return g * a + (1 - g) * b
```

```asm
; @launch grid=(256,1,1) block=(256,1,1) lds=163840
.amdgcn_target "amdgcn-amd-amdhsa--gfx950"
.text
.globl gated_mix__ssm_conv_s5__dense_activation_squared_relu__prompt_kernel
.p2align 8
.type gated_mix__ssm_conv_s5__dense_activation_squared_relu__prompt_kernel,@function
gated_mix__ssm_conv_s5__dense_activation_squared_relu__prompt_kernel:
    s_cmp_ge_u32 s2, 256
    s_cbranch_scc1 L_end
    s_load_dwordx2 s[4:5], s[0:1], 0
    s_load_dwordx2 s[8:9], s[0:1], 24
    s_load_dwordx2 s[12:13], s[0:1], 32
    v_and_b32 v1, 63, v0
    v_lshrrev_b32 v33, 6, v0
    s_and_b32 s70, s2, 7
    s_lshr_b32 s71, s2, 3
    v_readfirstlane_b32 s60, v33
    s_nop 3
    s_cmp_lg_u32 s60, 3
    s_cbranch_scc1 L_nopf
    s_getpc_b64 s[88:89]
    s_lshr_b32 s72, s2, 3
    s_lshl_b32 s72, s72, 10
    s_add_u32 s88, s88, s72
    s_addc_u32 s89, s89, 0
    v_lshlrev_b32 v33, 7, v1
    v_mov_b32 v35, s89
    v_add_co_u32 v34, vcc, s88, v33
    s_nop 1
    v_addc_co_u32 v35, vcc, 0, v35, vcc
    s_mov_b64 exec, 0xff
    global_load_dword v56, v[34:35], off
    s_mov_b64 exec, -1
L_nopf:
    s_and_b32 s72, s70, 1
    s_lshl_b32 s72, s72, 3
    s_and_b32 s62, s71, 7
    s_add_u32 s58, s72, s62
    s_lshr_b32 s72, s70, 1
    s_lshl_b32 s72, s72, 2
    s_lshr_b32 s73, s71, 3
    s_add_u32 s59, s72, s73
    s_lshl_b32 s72, s70, 2
    s_add_u32 s61, s72, s73
    s_lshl_b32 s72, s73, 1
    s_add_u32 s72, s72, s58
    s_lshr_b32 s73, s70, 1
    s_add_u32 s72, s72, s73
    s_and_b32 s3, s72, 7
    v_lshrrev_b32 v33, 3, v1
    v_and_b32 v34, 7, v1
    v_lshrrev_b32 v35, 1, v33
    v_xor_b32 v34, v34, v35
    v_lshlrev_b32 v34, 4, v34
    v_lshrrev_b32 v35, 2, v33
    v_and_b32 v36, 3, v33
    v_lshl_add_u32 v35, v35, 4, v36
    s_lshl_b32 s72, s58, 7
    s_lshl_b32 s73, s60, 5
    s_add_u32 s72, s72, s73
    v_add_u32 v35, s72, v35
    v_lshl_add_u32 v2, v35, 10, v34
    v_xor_b32_e64 v36, 64, v2
    v_add_u32 v3, 3072, v36
    v_add_u32 v4, 6144, v2
    v_add_u32 v5, 9216, v36
    s_lshl_b32 s72, s59, 5
    s_lshl_b32 s73, s60, 3
    s_add_u32 s72, s72, s73
    v_add_u32 v33, s72, v33
    v_lshl_add_u32 v6, v33, 10, v34
    s_and_b32 s72, s60, 1
    s_lshl_b32 s72, s72, 6
    v_xor_b32_e64 v6, s72, v6
    s_mul_i32 s64, s60, 6144
    s_add_u32 s72, s3, 0
    s_and_b32 s72, s72, 7
    s_lshl_b32 s92, s72, 7
    s_add_u32 s72, s3, 1
    s_and_b32 s72, s72, 7
    s_lshl_b32 s93, s72, 7
    s_mov_b32 s6, 0x200000
    s_mov_b32 s7, 0x20000
    s_mov_b32 s10, 0x80000
    s_mov_b32 s11, 0x20000
    s_mov_b32 s14, 0x80400
    s_mov_b32 s15, 0x20000
    s_waitcnt lgkmcnt(0)
    s_sub_u32 s12, s12, 1024
    s_subb_u32 s13, s13, 0
    s_add_u32 m0, s64, 0
    s_nop 0
    buffer_load_dwordx4 v2, s[4:7], s92 offen lds
    buffer_load_dwordx4 v3, s[4:7], s92 offen offset:1024 lds
    buffer_load_dwordx4 v4, s[4:7], s92 offen offset:2048 lds
    buffer_load_dwordx4 v5, s[4:7], s92 offen offset:3072 lds
    s_add_u32 m0, s64, 4096
    s_nop 0
    buffer_load_dwordx4 v6, s[8:11], s92 offen lds
    buffer_load_dwordx4 v6, s[12:15], s92 offen offset:1024 lds
    s_load_dwordx2 s[16:17], s[0:1], 80
    s_load_dwordx2 s[20:21], s[0:1], 96
    s_load_dwordx2 s[24:25], s[0:1], 40
    s_load_dwordx2 s[28:29], s[0:1], 48
    s_load_dwordx2 s[40:41], s[0:1], 128
    s_load_dwordx2 s[32:33], s[0:1], 136
    s_load_dwordx2 s[44:45], s[0:1], 8
    s_load_dwordx2 s[46:47], s[0:1], 16
    s_load_dwordx2 s[48:49], s[0:1], 56
    s_load_dwordx2 s[52:53], s[0:1], 88
    s_load_dwordx2 s[56:57], s[0:1], 112
    s_load_dwordx2 s[36:37], s[0:1], 120
    s_load_dwordx2 s[74:75], s[0:1], 64
    s_load_dwordx2 s[76:77], s[0:1], 104
    s_mov_b32 s18, 0x1c0000
    s_mov_b32 s19, 0x20000
    s_mov_b32 s22, 0x1c0000
    s_mov_b32 s23, 0x20000
    s_mov_b32 s26, 0x80000
    s_mov_b32 s27, 0x20000
    s_mov_b32 s30, 0x80000
    s_mov_b32 s31, 0x20000
    s_mov_b32 s34, 0xc00000
    s_mov_b32 s35, 0x20000
    s_mov_b32 s38, 0x400000
    s_mov_b32 s39, 0x20000
    s_mov_b32 s42, 0x100
    s_mov_b32 s43, 0x20000
    v_and_b32 v50, 31, v1
    v_lshrrev_b32 v51, 5, v1
    v_lshrrev_b32 v52, 5, v0
    v_bfe_u32 v33, v50, 1, 3
    v_xor_b32 v33, v33, v51
    v_lshlrev_b32 v33, 4, v33
    v_lshl_add_u32 v34, v50, 7, v33
    v_add_u32 v14, s64, v34
    v_lshrrev_b32 v35, 3, v50
    v_mul_u32_u24 v35, 6144, v35
    v_and_b32_e64 v36, 7, v50
    v_lshl_add_u32 v36, v36, 7, v33
    v_add_u32 v35, v35, v36
    v_add_u32 v22, 4096, v35
    v_xor_b32 v15, 32, v14
    v_xor_b32 v23, 32, v22
    v_xor_b32 v16, 64, v14
    v_xor_b32_e64 v24, 64, v22
    v_xor_b32 v17, 96, v14
    v_xor_b32 v25, 96, v22
    v_add_u32 v18, 73728, v14
    v_add_u32 v26, 73728, v22
    v_add_u32 v19, 73728, v15
    v_add_u32 v27, 73728, v23
    v_add_u32 v20, 73728, v16
    v_add_u32 v28, 73728, v24
    v_add_u32 v21, 73728, v17
    v_add_u32 v29, 73728, v25
    s_waitcnt lgkmcnt(0)
    v_and_b32 v50, 31, v1
    v_lshrrev_b32 v51, 5, v1
    v_lshrrev_b32_e64 v52, 5, v0
    s_lshl_b32 s72, s59, 6
    v_lshl_add_u32 v33, v50, 1, s72
    global_load_ushort v176, v33, s[44:45]
    global_load_ushort v177, v33, s[46:47]
    global_load_ushort v178, v33, s[48:49]
    v_and_b32 v53, 127, v0
    s_mul_i32 s72, s59, 112
    v_add_u32 v33, s72, v53
    v_min_u32 v33, 1791, v33
    v_lshlrev_b32 v33, 1, v33
    global_load_ushort v179, v33, s[52:53]
    s_lshl_b32 s72, s58, 7
    s_lshl_b32 s73, s59, 3
    s_add_u32 s72, s72, s73
    s_lshl_b32 s73, s60, 1
    s_add_u32 s86, s72, s73
    v_lshlrev_b32 v54, 4, v1
    s_mov_b32 s80, s56
    s_mov_b32 s81, s57
    s_lshl_b32 s72, s62, 7
    v_and_b32 v33, 15, v1
    v_lshlrev_b32 v33, 3, v33
    v_add_u32 v33, s72, v33
    global_load_dwordx2 v[250:251], v33, s[74:75]
    global_load_dwordx2 v[252:253], v33, s[76:77]
    s_or_b32 s72, s2, s60
    s_cmp_lg_u32 s72, 0
    s_cbranch_scc1 L_nononce
    s_memrealtime s[90:91]
    s_waitcnt lgkmcnt(0)
    s_or_b32 s72, s90, 1
    v_mov_b32 v33, s72
    v_mov_b32 v34, 0
    s_mov_b64 exec, 1
    buffer_store_dword v33, v34, s[40:43], 0 offen sc0 sc1
    s_mov_b64 exec, -1
L_nononce:
    s_add_u32 s72, s3, 2
    s_and_b32 s72, s72, 7
    s_lshl_b32 s94, s72, 7
    s_add_u32 s72, s3, 3
    s_and_b32 s72, s72, 7
    s_lshl_b32 s95, s72, 7
    s_add_u32 s72, s3, 4
    s_and_b32 s72, s72, 7
    s_lshl_b32 s96, s72, 7
    s_add_u32 s72, s3, 5
    s_and_b32 s72, s72, 7
    s_lshl_b32 s97, s72, 7
    s_add_u32 s72, s3, 6
    s_and_b32 s72, s72, 7
    s_lshl_b32 s98, s72, 7
    s_add_u32 s72, s3, 7
    s_and_b32 s72, s72, 7
    s_lshl_b32 s99, s72, 7
    v_mov_b32 v60, 0
    v_mov_b32 v61, 0
    v_lshlrev_b32 v59, 3, v0
    v_add_u32 v59, 151552, v59
    ds_write_b64 v59, v[60:61]
    s_add_u32 m0, s64, 24576
    s_nop 0
    buffer_load_dwordx4 v2, s[4:7], s93 offen lds
    buffer_load_dwordx4 v3, s[4:7], s93 offen offset:1024 lds
    buffer_load_dwordx4 v4, s[4:7], s93 offen offset:2048 lds
    buffer_load_dwordx4 v5, s[4:7], s93 offen offset:3072 lds
    s_add_u32 m0, s64, 28672
    s_nop 0
    buffer_load_dwordx4 v6, s[8:11], s93 offen lds
    buffer_load_dwordx4 v6, s[12:15], s93 offen offset:1024 lds
    s_waitcnt vmcnt(12)
    s_waitcnt lgkmcnt(0)
    s_barrier
    ds_read_b128 a[0:3], v14 offset:0
    ds_read_b128 a[128:131], v22 offset:0
    ds_read_b128 a[132:135], v22 offset:1024
    ds_read_b128 a[4:7], v15 offset:0
    ds_read_b128 a[136:139], v23 offset:0
    ds_read_b128 a[140:143], v23 offset:1024
    ds_read_b128 a[8:11], v16 offset:0
    ds_read_b128 a[144:147], v24 offset:0
    ds_read_b128 a[148:151], v24 offset:1024
    ds_read_b128 a[12:15], v17 offset:0
    ds_read_b128 a[152:155], v25 offset:0
    ds_read_b128 a[156:159], v25 offset:1024
    s_waitcnt lgkmcnt(6)
    v_mfma_f32_32x32x16_bf16 v[64:79], a[0:3], a[128:131], 0
    s_add_u32 m0, s64, 49152
    s_nop 0
    buffer_load_dwordx4 v2, s[4:7], s94 offen lds
    s_mul_i32 s65, s60, 36864
    s_lshl_b32 s66, s60, 12
    s_mul_i32 s67, s60, 7168
    s_lshl_b32 s72, s3, 1
    s_add_u32 s100, s72, s60
    v_mfma_f32_32x32x16_bf16 v[80:95], a[0:3], a[132:135], 0
    buffer_load_dwordx4 v3, s[4:7], s94 offen offset:1024 lds
    buffer_load_dwordx4 v4, s[4:7], s94 offen offset:2048 lds
    s_mul_i32 s85, s59, 224
    v_add_u32 v59, 0, v1
    v_mul_u32_u24 v60, 4682, v59
    v_lshrrev_b32 v60, 16, v60
    v_mul_u32_u24_e64 v61, 14, v60
    v_mfma_f32_32x32x16_bf16 v[64:79], a[4:7], a[136:139], v[64:79]
    buffer_load_dwordx4 v5, s[4:7], s94 offen offset:3072 lds
    s_add_u32 m0, s64, 53248
    s_nop 0
    buffer_load_dwordx4 v6, s[8:11], s94 offen lds
    v_sub_u32 v61, v59, v61
    v_and_b32 v62, 24, v60
    v_bfe_u32 v63, v60, 1, 2
    v_and_b32 v60, 1, v60
    v_lshl_add_u32 v62, v60, 2, v62
    v_mfma_f32_32x32x16_bf16 v[80:95], a[4:7], a[140:143], v[80:95]
    buffer_load_dwordx4 v6, s[12:15], s94 offen offset:1024 lds
    v_add_u32 v62, v62, v63
    v_mul_u32_u24 v62, 3584, v62
    v_lshl_add_u32 v62, v61, 4, v62
    v_add_u32 v7, s85, v62
    v_add_u32 v59, 64, v1
    s_waitcnt lgkmcnt(0)
    v_mfma_f32_32x32x16_bf16 v[64:79], a[8:11], a[144:147], v[64:79]
    s_waitcnt vmcnt(6)
    s_barrier
    ds_read_b128 a[16:19], v14 offset:24576
    ds_read_b128 a[160:163], v22 offset:24576
    ds_read_b128 a[164:167], v22 offset:25600
    s_add_u32 m0, s64, 73728
    s_nop 0
    buffer_load_dwordx4 v2, s[4:7], s95 offen lds
    v_mul_u32_u24 v60, 4682, v59
    v_lshrrev_b32 v60, 16, v60
    v_mul_u32_u24 v61, 14, v60
    v_sub_u32 v61, v59, v61
    v_and_b32_e64 v62, 24, v60
    v_mfma_f32_32x32x16_bf16 v[80:95], a[8:11], a[148:151], v[80:95]
    ds_read_b128 a[20:23], v15 offset:24576
    ds_read_b128 a[168:171], v23 offset:24576
    ds_read_b128 a[172:175], v23 offset:25600
    buffer_load_dwordx4 v3, s[4:7], s95 offen offset:1024 lds
    buffer_load_dwordx4 v4, s[4:7], s95 offen offset:2048 lds
    v_bfe_u32 v63, v60, 1, 2
    v_and_b32_e64 v60, 1, v60
    v_lshl_add_u32 v62, v60, 2, v62
    v_add_u32_e64 v62, v62, v63
    v_mul_u32_u24 v62, 3584, v62
    v_mfma_f32_32x32x16_bf16 v[64:79], a[12:15], a[152:155], v[64:79]
    ds_read_b128 a[24:27], v16 offset:24576
    ds_read_b128 a[176:179], v24 offset:24576
    ds_read_b128 a[180:183], v24 offset:25600
    buffer_load_dwordx4 v5, s[4:7], s95 offen offset:3072 lds
    s_add_u32 m0, s64, 77824
    s_nop 0
    buffer_load_dwordx4 v6, s[8:11], s95 offen lds
    v_lshl_add_u32 v62, v61, 4, v62
    v_subrev_u32 v62, 1024, v62
    v_add_u32 v8, s85, v62
    v_add_u32 v59, 128, v1
    v_mul_u32_u24 v60, 4682, v59
    v_mfma_f32_32x32x16_bf16 v[80:95], a[12:15], a[156:159], v[80:95]
    ds_read_b128 a[28:31], v17 offset:24576
    ds_read_b128 a[184:187], v25 offset:24576
    ds_read_b128 a[188:191], v25 offset:25600
    buffer_load_dwordx4 v6, s[12:15], s95 offen offset:1024 lds
    v_lshrrev_b32 v60, 16, v60
    v_mul_u32_u24 v61, 14, v60
    v_sub_u32 v61, v59, v61
    v_and_b32_e64 v62, 24, v60
    v_bfe_u32 v63, v60, 1, 2
    s_waitcnt lgkmcnt(6)
    v_mfma_f32_32x32x16_bf16 v[64:79], a[16:19], a[160:163], v[64:79]
    s_add_u32 m0, s64, 98304
    s_nop 0
    buffer_load_dwordx4 v2, s[4:7], s96 offen lds
    v_and_b32 v60, 1, v60
    v_lshl_add_u32 v62, v60, 2, v62
    v_add_u32_e64 v62, v62, v63
    v_mul_u32_u24 v62, 3584, v62
    v_lshl_add_u32 v62, v61, 4, v62
    v_mfma_f32_32x32x16_bf16 v[80:95], a[16:19], a[164:167], v[80:95]
    buffer_load_dwordx4 v3, s[4:7], s96 offen offset:1024 lds
    v_subrev_u32 v62, 2048, v62
    v_add_u32_e64 v9, s85, v62
    v_add_u32 v59, 192, v1
    v_mul_u32_u24 v60, 4682, v59
    v_lshrrev_b32_e64 v60, 16, v60
    v_mfma_f32_32x32x16_bf16 v[64:79], a[20:23], a[168:171], v[64:79]
    buffer_load_dwordx4 v4, s[4:7], s96 offen offset:2048 lds
    v_mul_u32_u24 v61, 14, v60
    v_sub_u32 v61, v59, v61
    v_and_b32 v62, 24, v60
    v_bfe_u32 v63, v60, 1, 2
    v_and_b32 v60, 1, v60
    v_mfma_f32_32x32x16_bf16 v[80:95], a[20:23], a[172:175], v[80:95]
    buffer_load_dwordx4 v5, s[4:7], s96 offen offset:3072 lds
    v_lshl_add_u32 v62, v60, 2, v62
    v_add_u32_e64 v62, v62, v63
    v_mul_u32_u24 v62, 3584, v62
    v_lshl_add_u32 v62, v61, 4, v62
    v_subrev_u32 v62, 3072, v62
    s_waitcnt lgkmcnt(0)
    v_mfma_f32_32x32x16_bf16 v[64:79], a[24:27], a[176:179], v[64:79]
    s_waitcnt vmcnt(10)
    s_barrier
    ds_read_b128 a[32:35], v14 offset:49152
    ds_read_b128 a[128:131], v22 offset:49152
    ds_read_b128 a[132:135], v22 offset:50176
    s_add_u32 m0, s64, 102400
    s_nop 0
    buffer_load_dwordx4 v6, s[8:11], s96 offen lds
    v_add_u32_e64 v10, s85, v62
    v_add_u32 v59, 256, v1
    v_mul_u32_u24 v60, 4682, v59
    v_lshrrev_b32 v60, 16, v60
    v_mul_u32_u24 v61, 14, v60
    v_mfma_f32_32x32x16_bf16 v[80:95], a[24:27], a[180:183], v[80:95]
    ds_read_b128 a[36:39], v15 offset:49152
    ds_read_b128 a[136:139], v23 offset:49152
    ds_read_b128 a[140:143], v23 offset:50176
    buffer_load_dwordx4 v6, s[12:15], s96 offen offset:1024 lds
    v_sub_u32 v61, v59, v61
    v_and_b32 v62, 24, v60
    v_bfe_u32 v63, v60, 1, 2
    v_and_b32_e64 v60, 1, v60
    v_lshl_add_u32 v62, v60, 2, v62
    v_mfma_f32_32x32x16_bf16 v[64:79], a[28:31], a[184:187], v[64:79]
    ds_read_b128 a[40:43], v16 offset:49152
    ds_read_b128 a[144:147], v24 offset:49152
    ds_read_b128 a[148:151], v24 offset:50176
    v_add_u32 v62, v62, v63
    v_mul_u32_u24 v62, 3584, v62
    v_lshl_add_u32 v62, v61, 4, v62
    v_add_u32 v11, s85, v62
    v_add_u32 v59, 320, v1
    v_mfma_f32_32x32x16_bf16 v[80:95], a[28:31], a[188:191], v[80:95]
    ds_read_b128 a[44:47], v17 offset:49152
    ds_read_b128 a[152:155], v25 offset:49152
    ds_read_b128 a[156:159], v25 offset:50176
    v_mul_u32_u24 v60, 4682, v59
    v_lshrrev_b32 v60, 16, v60
    v_mul_u32_u24 v61, 14, v60
    v_sub_u32 v61, v59, v61
    v_and_b32_e64 v62, 24, v60
    s_waitcnt lgkmcnt(6)
    v_mfma_f32_32x32x16_bf16 v[64:79], a[32:35], a[128:131], v[64:79]
    s_add_u32 m0, s64, 0
    s_nop 0
    buffer_load_dwordx4 v2, s[4:7], s97 offen lds
    v_bfe_u32 v63, v60, 1, 2
    v_and_b32 v60, 1, v60
    v_lshl_add_u32 v62, v60, 2, v62
    v_add_u32 v62, v62, v63
    v_mul_u32_u24 v62, 3584, v62
    v_mfma_f32_32x32x16_bf16 v[80:95], a[32:35], a[132:135], v[80:95]
    buffer_load_dwordx4 v3, s[4:7], s97 offen offset:1024 lds
    v_lshl_add_u32 v62, v61, 4, v62
    v_subrev_u32 v62, 1024, v62
    v_add_u32_e64 v12, s85, v62
    v_add_u32 v59, 384, v1
    v_mul_u32_u24 v60, 4682, v59
    v_mfma_f32_32x32x16_bf16 v[64:79], a[36:39], a[136:139], v[64:79]
    buffer_load_dwordx4 v4, s[4:7], s97 offen offset:2048 lds
    v_lshrrev_b32 v60, 16, v60
    v_mul_u32_u24 v61, 14, v60
    v_sub_u32 v61, v59, v61
    v_and_b32 v62, 24, v60
    v_bfe_u32 v63, v60, 1, 2
    v_mfma_f32_32x32x16_bf16 v[80:95], a[36:39], a[140:143], v[80:95]
    buffer_load_dwordx4 v5, s[4:7], s97 offen offset:3072 lds
    v_and_b32 v60, 1, v60
    v_lshl_add_u32 v62, v60, 2, v62
    v_add_u32 v62, v62, v63
    v_mul_u32_u24 v62, 3584, v62
    v_lshl_add_u32 v62, v61, 4, v62
    s_waitcnt lgkmcnt(0)
    v_mfma_f32_32x32x16_bf16 v[64:79], a[40:43], a[144:147], v[64:79]
    s_waitcnt vmcnt(10)
    s_barrier
    ds_read_b128 a[48:51], v18 offset:0
    ds_read_b128 a[160:163], v26 offset:0
    ds_read_b128 a[164:167], v26 offset:1024
    s_add_u32 m0, s64, 4096
    s_nop 0
    buffer_load_dwordx4 v6, s[8:11], s97 offen lds
    v_subrev_u32 v62, 2048, v62
    v_add_u32_e64 v13, s85, v62
    v_mul_u32_u24 v59, 1792, v51
    v_bfe_u32 v60, v1, 2, 2
    v_mul_u32_u24 v60, 448, v60
    v_mfma_f32_32x32x16_bf16 v[80:95], a[40:43], a[148:151], v[80:95]
    ds_read_b128 a[52:55], v19 offset:0
    ds_read_b128 a[168:171], v27 offset:0
    ds_read_b128 a[172:175], v27 offset:1024
    buffer_load_dwordx4 v6, s[12:15], s97 offen offset:1024 lds
    s_lshl_b32 s101, s86, 10
    buffer_load_dwordx4 v[180:183], v54, s[4:7], s101 offen
    v_add_u32 v59, v59, v60
    v_bfe_u32 v60, v1, 4, 1
    v_lshl_add_u32 v59, v60, 5, v59
    v_and_b32_e64 v60, 3, v1
    v_lshl_add_u32 v30, v60, 3, v59
    v_mfma_f32_32x32x16_bf16 v[64:79], a[44:47], a[152:155], v[64:79]
    ds_read_b128 a[56:59], v20 offset:0
    ds_read_b128 a[176:179], v28 offset:0
    ds_read_b128 a[180:183], v28 offset:1024
    buffer_load_dwordx4 v[184:187], v54, s[4:7], s101 offen offset:1024
    v_add_u32 v31, 73728, v30
    v_add_u32 v32, 122880, v30
    s_and_b32 s72, s61, 3
    s_mul_i32 s72, s72, 7
    s_lshr_b32 s72, s72, 1
    s_lshr_b32 s73, s61, 2
    s_mul_i32 s73, s73, 7
    s_lshr_b32 s73, s73, 2
    s_add_u32 s72, s72, s73
    s_cmp_ge_u32 s72, 14
    s_cselect_b32 s73, 14, 0
    s_sub_u32 s72, s72, s73
    s_lshl_b32 s44, s72, 11
    v_mfma_f32_32x32x16_bf16 v[80:95], a[44:47], a[156:159], v[80:95]
    ds_read_b128 a[60:63], v21 offset:0
    ds_read_b128 a[184:187], v29 offset:0
    ds_read_b128 a[188:191], v29 offset:1024
    global_load_dwordx4 v[188:191], v54, s[80:81]
    s_add_u32 s45, s44, 2048
    s_cmp_eq_u32 s45, 28672
    s_cselect_b32 s45, 0, s45
    s_waitcnt lgkmcnt(6)
    v_mfma_f32_32x32x16_bf16 v[64:79], a[48:51], a[160:163], v[64:79]
    s_add_u32 m0, s64, 24576
    s_nop 0
    buffer_load_dwordx4 v2, s[4:7], s98 offen lds
    s_add_u32 s46, s45, 2048
    s_cmp_eq_u32 s46, 28672
    s_cselect_b32 s46, 0, s46
    s_add_u32 s47, s46, 2048
    s_cmp_eq_u32 s47, 28672
    s_cselect_b32 s47, 0, s47
    s_add_u32 s48, s47, 2048
    s_cmp_eq_u32 s48, 28672
    s_cselect_b32 s48, 0, s48
    v_mfma_f32_32x32x16_bf16 v[80:95], a[48:51], a[164:167], v[80:95]
    buffer_load_dwordx4 v3, s[4:7], s98 offen offset:1024 lds
    s_add_u32 s49, s48, 2048
    s_cmp_eq_u32 s49, 28672
    s_cselect_b32 s49, 0, s49
    s_add_u32 s50, s49, 2048
    s_cmp_eq_u32 s50, 28672
    s_cselect_b32 s50, 0, s50
    v_mfma_f32_32x32x16_bf16 v[64:79], a[52:55], a[168:171], v[64:79]
    buffer_load_dwordx4 v4, s[4:7], s98 offen offset:2048 lds
    s_add_u32 s51, s50, 2048
    s_cmp_eq_u32 s51, 28672
    s_cselect_b32 s51, 0, s51
    s_add_u32 s52, s51, 2048
    s_cmp_eq_u32 s52, 28672
    s_cselect_b32 s52, 0, s52
    s_add_u32 s53, s52, 2048
    s_cmp_eq_u32 s53, 28672
    s_cselect_b32 s53, 0, s53
    v_mfma_f32_32x32x16_bf16 v[80:95], a[52:55], a[172:175], v[80:95]
    buffer_load_dwordx4 v5, s[4:7], s98 offen offset:3072 lds
    s_add_u32 s54, s53, 2048
    s_cmp_eq_u32 s54, 28672
    s_cselect_b32 s54, 0, s54
    s_add_u32 s55, s54, 2048
    s_cmp_eq_u32 s55, 28672
    s_cselect_b32 s55, 0, s55
    s_waitcnt lgkmcnt(0)
    v_mfma_f32_32x32x16_bf16 v[64:79], a[56:59], a[176:179], v[64:79]
    s_waitcnt vmcnt(13)
    s_barrier
    ds_read_b128 a[64:67], v18 offset:24576
    ds_read_b128 a[128:131], v26 offset:24576
    ds_read_b128 a[132:135], v26 offset:25600
    s_add_u32 m0, s64, 28672
    s_nop 0
    buffer_load_dwordx4 v6, s[8:11], s98 offen lds
    s_add_u32 s56, s55, 2048
    s_cmp_eq_u32 s56, 28672
    s_cselect_b32 s56, 0, s56
    s_add_u32 s57, s56, 2048
    s_cmp_eq_u32 s57, 28672
    s_cselect_b32 s57, 0, s57
    s_lshl_b32 s72, s59, 13
    s_add_u32 s87, s72, 11550720
    v_mfma_f32_32x32x16_bf16 v[80:95], a[56:59], a[180:183], v[80:95]
    ds_read_b128 a[68:71], v19 offset:24576
    ds_read_b128 a[136:139], v27 offset:24576
    ds_read_b128 a[140:143], v27 offset:25600
    buffer_load_dwordx4 v6, s[12:15], s98 offen offset:1024 lds
    s_lshl_b32 s72, s58, 2
    s_add_u32 s72, s72, s60
    s_mul_i32 s72, s72, 180224
    s_mul_i32 s73, s59, 7168
    s_add_u32 s82, s72, s73
    s_add_u32 s83, s82, 4096
    s_lshl_b32 s73, s59, 12
    s_add_u32 s72, s72, s73
    s_add_u32 s84, s72, 114688
    v_mfma_f32_32x32x16_bf16 v[64:79], a[60:63], a[184:187], v[64:79]
    ds_read_b128 a[72:75], v20 offset:24576
    ds_read_b128 a[144:147], v28 offset:24576
    ds_read_b128 a[148:151], v28 offset:25600
    v_lshlrev_b32 v176, 16, v176
    v_lshlrev_b32 v177, 16, v177
    v_lshlrev_b32 v178, 16, v178
    v_lshlrev_b32 v179, 16, v179
    v_lshlrev_b32_e64 v53, 2, v53
    v_add_u32 v53, 155392, v53
    ds_write_b32 v53, v179
    v_mfma_f32_32x32x16_bf16 v[80:95], a[60:63], a[188:191], v[80:95]
    ds_read_b128 a[76:79], v21 offset:24576
    ds_read_b128 a[152:155], v29 offset:24576
    ds_read_b128 a[156:159], v29 offset:25600
    v_mul_f32 v178, 0x3fb8aa3b, v178
    v_exp_f32 v178, v178
    v_cvt_f32_u32 v62, v52
    v_cvt_pk_bf16_f32 v178, v178, v178
    v_lshlrev_b32 v178, 16, v178
    v_mul_f32 v57, v178, v176
    v_mul_f32_e64 v58, v178, v177
    s_waitcnt lgkmcnt(7)
    v_mfma_f32_32x32x16_bf16 v[64:79], a[64:67], a[128:131], v[64:79]
    s_add_u32 m0, s64, 49152
    s_nop 0
    buffer_load_dwordx4 v2, s[4:7], s99 offen lds
    v_mul_f32 v57, 0x3fb8aa3b, v57
    v_mul_f32 v58, 0.15915494, v58
    v_mov_b32 v59, 1.0
    v_mul_f32 v60, v59, v57
    v_mul_f32 v61, v59, v58
    v_exp_f32 v60, v60
    v_fract_f32 v61, v61
    v_mfma_f32_32x32x16_bf16 v[80:95], a[64:67], a[132:135], v[80:95]
    buffer_load_dwordx4 v3, s[4:7], s99 offen offset:1024 lds
    v_cos_f32 v33, v61
    v_sin_f32 v34, v61
    v_mul_f32 v33, v33, v60
    v_mul_f32 v34, v34, v60
    v_mov_b32 v59, 0x41800000
    v_mul_f32 v60, v59, v57
    v_mul_f32 v61, v59, v58
    v_mfma_f32_32x32x16_bf16 v[64:79], a[68:71], a[136:139], v[64:79]
    buffer_load_dwordx4 v4, s[4:7], s99 offen offset:2048 lds
    v_exp_f32 v60, v60
    v_fract_f32 v61, v61
    v_cos_f32 v35, v61
    v_sin_f32 v36, v61
    v_mul_f32 v35, v35, v60
    v_mul_f32 v36, v36, v60
    v_mul_f32 v59, 0x41800000, v62
    v_mfma_f32_32x32x16_bf16 v[80:95], a[68:71], a[140:143], v[80:95]
    buffer_load_dwordx4 v5, s[4:7], s99 offen offset:3072 lds
    v_mul_f32 v60, v59, v57
    v_mul_f32 v61, v59, v58
    v_exp_f32 v60, v60
    v_fract_f32 v61, v61
    v_cos_f32 v37, v61
    v_sin_f32 v38, v61
    v_mul_f32 v37, v37, v60
    s_waitcnt lgkmcnt(0)
    v_mfma_f32_32x32x16_bf16 v[64:79], a[72:75], a[144:147], v[64:79]
    s_waitcnt vmcnt(13)
    s_barrier
    ds_read_b128 a[80:83], v14 offset:0
    ds_read_b128 a[160:163], v22 offset:0
    ds_read_b128 a[164:167], v22 offset:1024
    s_add_u32 m0, s64, 53248
    s_nop 0
    buffer_load_dwordx4 v6, s[8:11], s99 offen lds
    v_mul_f32 v38, v38, v60
    s_sub_u32 s72, s58, 1
    v_sub_u32 v59, s72, v52
    v_max_i32 v59, 0, v59
    v_lshlrev_b32 v59, 7, v59
    v_cvt_f32_u32 v59, v59
    v_mul_f32 v60, v59, v57
    v_mfma_f32_32x32x16_bf16 v[80:95], a[72:75], a[148:151], v[80:95]
    ds_read_b128 a[84:87], v15 offset:0
    ds_read_b128 a[168:171], v23 offset:0
    ds_read_b128 a[172:175], v23 offset:1024
    buffer_load_dwordx4 v6, s[12:15], s99 offen offset:1024 lds
    v_mul_f32 v61, v59, v58
    v_exp_f32 v60, v60
    v_fract_f32 v61, v61
    v_cos_f32 v39, v61
    v_sin_f32 v40, v61
    v_mul_f32 v39, v39, v60
    v_mul_f32_e64 v40, v40, v60
    v_mfma_f32_32x32x16_bf16 v[64:79], a[76:79], a[152:155], v[64:79]
    ds_read_b128 a[88:91], v16 offset:0
    ds_read_b128 a[176:179], v24 offset:0
    ds_read_b128 a[180:183], v24 offset:1024
    buffer_load_dword v49, off, s[40:43], 0 sc0 sc1
    s_sub_u32 s72, s58, 9
    v_sub_u32 v59, s72, v52
    v_max_i32 v59, 0, v59
    v_lshlrev_b32 v59, 7, v59
    v_cvt_f32_u32 v59, v59
    v_mul_f32 v60, v59, v57
    v_mul_f32_e64 v61, v59, v58
    v_mfma_f32_32x32x16_bf16 v[80:95], a[76:79], a[156:159], v[80:95]
    ds_read_b128 a[92:95], v17 offset:0
    ds_read_b128 a[184:187], v25 offset:0
    ds_read_b128 a[188:191], v25 offset:1024
    v_exp_f32 v60, v60
    v_fract_f32 v61, v61
    v_cos_f32 v41, v61
    v_sin_f32 v42, v61
    v_mul_f32 v41, v41, v60
    v_mul_f32 v42, v42, v60
    v_add_f32 v59, -1.0, v33
    s_waitcnt lgkmcnt(6)
    v_mfma_f32_32x32x16_bf16 v[64:79], a[80:83], a[160:163], v[64:79]
    s_add_u32 s68, s100, 0
    s_and_b32 s68, s68, 15
    s_mul_i32 s68, s68, 114688
    s_add_u32 m0, s67, 122880
    s_nop 0
    buffer_load_dwordx4 v7, s[16:19], s68 offen lds
    v_mul_f32 v60, v176, v176
    v_fmac_f32 v60, v177, v177
    v_rcp_f32 v60, v60
    v_mul_f32 v61, v59, v176
    v_fmac_f32 v61, v34, v177
    v_mul_f32_e64 v62, v34, v176
    v_fma_f32 v62, -v59, v177, v62
    v_mfma_f32_32x32x16_bf16 v[80:95], a[80:83], a[164:167], v[80:95]
    v_add_f32 v60, v60, v60
    v_mul_f32 v43, v61, v60
    v_mul_f32_e64 v44, v62, v60
    v_cmp_gt_u32 s[74:75], s58, v52
    v_add_u32_e64 v59, 8, v52
    v_cmp_gt_u32 s[76:77], s58, v59
    v_mfma_f32_32x32x16_bf16 v[64:79], a[84:87], a[168:171], v[64:79]
    buffer_load_dwordx4 v8, s[16:19], s68 offen offset:1024 lds
    buffer_load_dwordx4 v9, s[16:19], s68 offen offset:2048 lds
    s_waitcnt vmcnt(16)
    v_and_b32 v192, 0xffff, v188
    v_and_b32 v193, 0xffff0000, v188
    v_and_b32 v194, 0xffff, v189
    v_and_b32 v195, 0xffff0000, v189
    v_and_b32 v196, 0xffff, v190
    v_and_b32 v197, 0xffff0000, v190
    v_and_b32 v198, 0xffff, v191
    s_add_u32 s72, s61, 0
    s_and_b32 s72, s72, 3
    s_lshl_b32 s96, s72, 12
    v_mfma_f32_32x32x16_bf16 v[80:95], a[84:87], a[172:175], v[80:95]
    buffer_load_dwordx4 v10, s[16:19], s68 offen offset:3072 lds
    s_add_u32 m0, s67, 126976
    s_nop 0
    buffer_load_dwordx4 v11, s[16:19], s68 offen lds
    v_and_b32 v199, 0xffff0000, v191
    v_mov_b32 v210, 0x3f803f80
    v_mov_b32 v200, 0
    v_mov_b32_e64 v201, 0
    v_dot2_f32_bf16 v212, v180, v192, 0
    v_dot2_f32_bf16 v213, v180, v193, 0
    v_dot2_f32_bf16 v216, v184, v192, 0
    s_lshr_b32 s72, s61, 2
    s_add_u32 s72, s72, 0
    s_and_b32 s72, s72, 3
    s_lshl_b32 s92, s72, 12
    s_waitcnt lgkmcnt(0)
    v_mfma_f32_32x32x16_bf16 v[64:79], a[88:91], a[176:179], v[64:79]
    s_waitcnt vmcnt(12)
    s_barrier
    ds_read_b128 a[96:99], v14 offset:24576
    ds_read_b128 a[128:131], v22 offset:24576
    ds_read_b128 a[132:135], v22 offset:25600
    buffer_load_dwordx4 v12, s[16:19], s68 offen offset:1024 lds
    v_dot2_f32_bf16 v217, v184, v193, 0
    v_dot2_f32_bf16 v220, v181, v194, 0
    v_dot2_f32_bf16 v221, v181, v195, 0
    v_cvt_pk_bf16_f32 v214, v212, v213
    v_dot2_f32_bf16 v224, v185, v194, 0
    v_dot2_f32_bf16 v225, v185, v195, 0
    v_cvt_pk_bf16_f32 v218, v216, v217
    v_mfma_f32_32x32x16_bf16 v[80:95], a[88:91], a[180:183], v[80:95]
    ds_read_b128 a[100:103], v15 offset:24576
    ds_read_b128 a[136:139], v23 offset:24576
    ds_read_b128 a[140:143], v23 offset:25600
    buffer_load_dwordx4 v13, s[16:19], s68 offen offset:2048 lds
    s_lshl_b32 s69, s2, 2
    s_add_u32 s69, s69, s60
    v_lshlrev_b32 v174, 7, v1
    s_mul_i32 s101, s69, 1792
    s_mov_b64 exec, 0x3fff
    buffer_load_dword v56, v174, s[20:23], s101 offen
    s_lshl_b32 s101, s69, 9
    s_mov_b64 exec, 15
    buffer_load_dword v56, v174, s[24:27], s101 offen
    buffer_load_dword v56, v174, s[28:31], s101 offen
    s_mov_b64 exec, -1
    v_dot2_f32_bf16 v212, v182, v196, 0
    v_dot2_f32_bf16 v213, v182, v197, 0
    v_cvt_pk_bf16_f32 v222, v220, v221
    v_dot2_f32_bf16 v200, v214, v210, v200
    v_dot2_f32_bf16 v216, v186, v196, 0
    v_dot2_f32_bf16 v217, v186, v197, 0
    v_cvt_pk_bf16_f32 v226, v224, v225
    s_add_u32 s72, s61, 1
    s_and_b32 s72, s72, 3
    s_lshl_b32 s97, s72, 12
    v_mfma_f32_32x32x16_bf16 v[64:79], a[92:95], a[184:187], v[64:79]
    ds_read_b128 a[104:107], v16 offset:24576
    ds_read_b128 a[144:147], v24 offset:24576
    ds_read_b128 a[148:151], v24 offset:25600
    v_dot2_f32_bf16 v201, v218, v210, v201
    v_dot2_f32_bf16 v220, v183, v198, 0
    v_dot2_f32_bf16 v221, v183, v199, 0
    v_cvt_pk_bf16_f32 v214, v212, v213
    v_dot2_f32_bf16 v200, v222, v210, v200
    v_dot2_f32_bf16 v224, v187, v198, 0
    v_dot2_f32_bf16 v225, v187, v199, 0
    s_lshr_b32 s72, s61, 2
    s_add_u32 s72, s72, 1
    s_and_b32 s72, s72, 3
    s_lshl_b32 s93, s72, 12
    v_mfma_f32_32x32x16_bf16 v[80:95], a[92:95], a[188:191], v[80:95]
    ds_read_b128 a[108:111], v17 offset:24576
    ds_read_b128 a[152:155], v25 offset:24576
    ds_read_b128 a[156:159], v25 offset:25600
    v_cvt_pk_bf16_f32 v218, v216, v217
    v_dot2_f32_bf16 v201, v226, v210, v201
    v_cvt_pk_bf16_f32 v222, v220, v221
    v_dot2_f32_bf16 v200, v214, v210, v200
    v_cvt_pk_bf16_f32 v226, v224, v225
    v_dot2_f32_bf16 v201, v218, v210, v201
    v_dot2_f32_bf16 v200, v222, v210, v200
    s_add_u32 s72, s61, 2
    s_and_b32 s72, s72, 3
    s_lshl_b32 s98, s72, 12
    s_waitcnt lgkmcnt(6)
    v_mfma_f32_32x32x16_bf16 v[64:79], a[96:99], a[128:131], v[64:79]
    v_dot2_f32_bf16 v201, v226, v210, v201
    v_add_f32 v200, v200, v200 row_shr:1 row_mask:0xf bank_mask:0xf bound_ctrl:0
    s_nop 1
    v_add_f32 v201, v201, v201 row_shr:1 row_mask:0xf bank_mask:0xf bound_ctrl:0
    v_add_f32 v200, v200, v200 row_shr:2 row_mask:0xf bank_mask:0xf bound_ctrl:0
    s_nop 0
    v_add_f32 v201, v201, v201 row_shr:2 row_mask:0xf bank_mask:0xf bound_ctrl:0
    v_add_f32 v200, v200, v200 row_shr:4 row_mask:0xf bank_mask:0xf bound_ctrl:0
    s_nop 0
    v_add_f32 v201, v201, v201 row_shr:4 row_mask:0xf bank_mask:0xf bound_ctrl:0
    v_lshlrev_b32 v175, 4, v51
    v_add_u32 v175, 155392, v175
    v_mfma_f32_32x32x16_bf16 v[80:95], a[96:99], a[132:135], v[80:95]
    v_add_f32 v200, v200, v200 row_shr:8 row_mask:0xf bank_mask:0xf bound_ctrl:0
    v_add_f32 v201, v201, v201 row_shr:8 row_mask:0xf bank_mask:0xf bound_ctrl:0
    s_nop 0
    v_add_f32 v200, v200, v200 row_bcast:15 row_mask:0xa bank_mask:0xf
    v_add_f32 v201, v201, v201 row_bcast:15 row_mask:0xa bank_mask:0xf
    s_nop 0
    v_add_f32 v200, v200, v200 row_bcast:31 row_mask:0xc bank_mask:0xf
    v_add_f32 v201, v201, v201 row_bcast:31 row_mask:0xc bank_mask:0xf
    v_cvt_pk_bf16_f32 v200, v200, v200
    s_lshr_b32 s72, s61, 2
    s_add_u32 s72, s72, 2
    s_and_b32 s72, s72, 3
    s_lshl_b32 s94, s72, 12
    ds_read_b128 v[96:99], v175 offset:0
    ds_read_b128 v[100:103], v175 offset:32
    v_mfma_f32_32x32x16_bf16 v[64:79], a[100:103], a[136:139], v[64:79]
    v_cvt_pk_bf16_f32 v201, v201, v201
    v_lshlrev_b32 v200, 16, v200
    v_lshlrev_b32 v201, 16, v201
    v_mul_f32 v200, 0xbfb8aa3b, v200
    v_mul_f32 v201, 0xbfb8aa3b, v201
    v_exp_f32 v200, v200
    v_exp_f32 v201, v201
    s_add_u32 s72, s61, 3
    s_and_b32 s72, s72, 3
    s_lshl_b32 s99, s72, 12
    ds_read_b128 v[104:107], v175 offset:64
    ds_read_b128 v[108:111], v175 offset:96
    v_mfma_f32_32x32x16_bf16 v[80:95], a[100:103], a[140:143], v[80:95]
    v_add_f32 v200, 1.0, v200
    v_add_f32 v201, 1.0, v201
    v_rcp_f32 v200, v200
    v_rcp_f32 v201, v201
    v_cvt_pk_bf16_f32 v200, v200, v200
    v_cvt_pk_bf16_f32 v201, v201, v201
    v_lshlrev_b32 v204, 16, v200
    s_lshr_b32 s72, s61, 2
    s_add_u32 s72, s72, 3
    s_and_b32 s72, s72, 3
    s_lshl_b32 s95, s72, 12
    ds_read_b128 v[112:115], v175 offset:128
    ds_read_b128 v[116:119], v175 offset:160
    s_waitcnt lgkmcnt(6)
    v_mfma_f32_32x32x16_bf16 v[64:79], a[104:107], a[144:147], v[64:79]
    s_waitcnt vmcnt(11)
    s_barrier
    ds_read_b128 a[112:115], v14 offset:49152
    ds_read_b128 a[160:163], v22 offset:49152
    ds_read_b128 a[164:167], v22 offset:50176
    v_lshlrev_b32 v206, 16, v201
    v_sub_f32 v200, 1.0, v204
    v_sub_f32 v201, 1.0, v206
    v_cvt_pk_bf16_f32 v200, v200, v200
    v_cvt_pk_bf16_f32 v201, v201, v201
    v_lshlrev_b32 v205, 16, v200
    v_lshlrev_b32 v207, 16, v201
    ds_read_b128 v[120:123], v175 offset:192
    ds_read_b128 v[124:127], v175 offset:224
    v_mfma_f32_32x32x16_bf16 v[80:95], a[104:107], a[148:151], v[80:95]
    ds_read_b128 a[116:119], v15 offset:49152
    ds_read_b128 a[168:171], v23 offset:49152
    ds_read_b128 a[172:175], v23 offset:50176
    v_mov_b32_e64 v202, 0
    s_lshl_b32 s101, s86, 3
    s_add_u32 s101, s101, 11534336
    s_mov_b32 exec_lo, 0
    s_mov_b32 exec_hi, 0x80000000
    buffer_store_dwordx2 v[204:205], v202, s[32:35], s101 offen sc1
    buffer_store_dwordx2 v[206:207], v202, s[32:35], s101 offen offset:8 sc1
    s_mov_b64 exec, -1
    ds_read_b128 v[128:131], v175 offset:256
    ds_read_b128 v[132:135], v175 offset:288
    v_mfma_f32_32x32x16_bf16 v[64:79], a[108:111], a[152:155], v[64:79]
    ds_read_b128 a[120:123], v16 offset:49152
    ds_read_b128 a[176:179], v24 offset:49152
    ds_read_b128 a[180:183], v24 offset:50176
    v_lshrrev_b32 v59, 3, v1
    v_and_b32 v60, 7, v1
    v_bfe_u32 v61, v59, 1, 1
    v_lshlrev_b32 v61, 2, v61
    v_xor_b32 v60, v60, v61
    v_lshlrev_b32 v60, 4, v60
    v_lshl_add_u32 v60, v59, 10, v60
    ds_read_b128 v[136:139], v175 offset:320
    ds_read_b128 v[140:143], v175 offset:352
    v_mfma_f32_32x32x16_bf16 v[80:95], a[108:111], a[156:159], v[80:95]
    ds_read_b128 a[124:127], v17 offset:49152
    ds_read_b128 a[184:187], v25 offset:49152
    ds_read_b128 a[188:191], v25 offset:50176
    s_mul_i32 s72, s60, 458752
    s_lshl_b32 s73, s62, 7
    s_add_u32 s72, s72, s73
    v_add_u32_e64 v2, s72, v60
    v_add_u32 v3, 7168, v2
    v_add_u32 v4, 14336, v2
    v_add_u32 v5, 21504, v2
    ds_read_b128 v[144:147], v175 offset:384
    ds_read_b128 v[148:151], v175 offset:416
    s_waitcnt lgkmcnt(12)
    v_mfma_f32_32x32x16_bf16 v[64:79], a[112:115], a[160:163], v[64:79]
    s_add_u32 s68, s100, 4
    s_and_b32 s68, s68, 15
    s_mul_i32 s68, s68, 114688
    s_add_u32 m0, s67, 73728
    s_nop 0
    buffer_load_dwordx4 v7, s[16:19], s68 offen lds
    v_bfe_u32 v59, v1, 2, 2
    v_lshl_add_u32 v60, v51, 2, v59
    v_lshlrev_b32_e64 v60, 7, v60
    v_bfe_u32 v61, v1, 4, 1
    v_lshlrev_b32 v61, 1, v61
    v_bfe_u32 v62, v1, 1, 1
    v_or_b32 v61, v61, v62
    ds_read_b128 v[152:155], v175 offset:448
    ds_read_b128 v[156:159], v175 offset:480
    v_mfma_f32_32x32x16_bf16 v[80:95], a[112:115], a[164:167], v[80:95]
    v_bfe_u32 v62, v59, 1, 1
    v_lshlrev_b32 v62, 2, v62
    v_xor_b32 v61, v61, v62
    v_lshl_add_u32 v60, v61, 4, v60
    v_and_b32_e64 v62, 1, v1
    v_lshl_add_u32 v184, v62, 3, v60
    v_mfma_f32_32x32x16_bf16 v[64:79], a[116:119], a[168:171], v[64:79]
    buffer_load_dwordx4 v8, s[16:19], s68 offen offset:1024 lds
    v_mfma_f32_32x32x16_bf16 v[80:95], a[116:119], a[172:175], v[80:95]
    buffer_load_dwordx4 v9, s[16:19], s68 offen offset:2048 lds
    s_waitcnt lgkmcnt(4)
    v_mfma_f32_32x32x16_bf16 v[64:79], a[120:123], a[176:179], v[64:79]
    s_waitcnt lgkmcnt(0)
    s_waitcnt vmcnt(8)
    s_barrier
    ds_read_b64_tr_b16 v[160:161], v32 offset:0
    ds_read_b64_tr_b16 v[162:163], v32 offset:224
    buffer_load_dwordx4 v10, s[16:19], s68 offen offset:3072 lds
    s_add_u32 m0, s67, 77824
    s_nop 0
    buffer_load_dwordx4 v11, s[16:19], s68 offen lds
    v_mfma_f32_32x32x16_bf16 v[80:95], a[120:123], a[180:183], v[80:95]
    ds_read_b64_tr_b16 v[164:165], v32 offset:64
    ds_read_b64_tr_b16 v[166:167], v32 offset:288
    v_mfma_f32_32x32x16_bf16 v[64:79], a[124:127], a[184:187], v[64:79]
    ds_read_b64_tr_b16 v[168:169], v32 offset:3584
    ds_read_b64_tr_b16 v[170:171], v32 offset:3808
    buffer_load_dwordx4 v12, s[16:19], s68 offen offset:1024 lds
    buffer_load_dwordx4 v13, s[16:19], s68 offen offset:2048 lds
    v_mfma_f32_32x32x16_bf16 v[80:95], a[124:127], a[188:191], v[80:95]
    ds_read_b64_tr_b16 v[172:173], v32 offset:3648
    ds_read_b64_tr_b16 v[174:175], v32 offset:3872
    s_waitcnt lgkmcnt(4)
    v_mfma_f32_32x32x16_bf16 v[96:111], v[160:163], a[0:3], v[96:111]
    ds_read_b64_tr_b16 v[176:177], v32 offset:7168
    ds_read_b64_tr_b16 v[178:179], v32 offset:7392
    s_add_u32 s69, s66, 57344
    v_add_u32 v14, s69, v184
    v_xor_b32 v15, 64, v14
    v_add_u32 v16, s65, v184
    v_xor_b32 v17, 64, v16
    s_add_u32 s68, s100, 8
    s_and_b32 s68, s68, 15
    s_mul_i32 s68, s68, 114688
    s_add_u32 m0, s67, 0
    s_nop 0
    buffer_load_dwordx4 v7, s[16:19], s68 offen lds
    v_mfma_f32_32x32x16_bf16 v[112:127], v[164:167], a[0:3], v[112:127]
    ds_read_b64_tr_b16 v[180:181], v32 offset:7232
    ds_read_b64_tr_b16 v[182:183], v32 offset:7456
    v_fma_f32 v60, v33, v64, v65
    v_fma_f32 v61, v33, v80, v81
    s_waitcnt lgkmcnt(4)
    v_mfma_f32_32x32x16_bf16 v[96:111], v[168:171], a[4:7], v[96:111]
    ds_read_b64_tr_b16 v[160:161], v32 offset:10752
    ds_read_b64_tr_b16 v[162:163], v32 offset:10976
    v_fma_f32 v46, -v34, v80, v60
    v_fma_f32 v47, v34, v64, v61
    v_mfma_f32_32x32x16_bf16 v[112:127], v[172:175], a[4:7], v[112:127]
    ds_read_b64_tr_b16 v[164:165], v32 offset:10816
    ds_read_b64_tr_b16 v[166:167], v32 offset:11040
    buffer_load_dwordx4 v8, s[16:19], s68 offen offset:1024 lds
    v_fma_f32 v60, v33, v46, v66
    v_fma_f32 v61, v33, v47, v82
    s_waitcnt lgkmcnt(4)
    v_mfma_f32_32x32x16_bf16 v[96:111], v[176:179], a[8:11], v[96:111]
    ds_read_b64_tr_b16 v[168:169], v32 offset:14336
    ds_read_b64_tr_b16 v[170:171], v32 offset:14560
    buffer_load_dwordx4 v9, s[16:19], s68 offen offset:2048 lds
    v_fma_f32 v62, -v34, v47, v60
    v_fma_f32 v63, v34, v46, v61
    v_mfma_f32_32x32x16_bf16 v[112:127], v[180:183], a[8:11], v[112:127]
    ds_read_b64_tr_b16 v[172:173], v32 offset:14400
    ds_read_b64_tr_b16 v[174:175], v32 offset:14624
    buffer_load_dwordx4 v10, s[16:19], s68 offen offset:3072 lds
    v_fma_f32 v60, v33, v62, v67
    v_fma_f32 v61, v33, v63, v83
    v_fma_f32 v46, -v34, v63, v60
    s_waitcnt lgkmcnt(4)
    v_mfma_f32_32x32x16_bf16 v[96:111], v[160:163], a[12:15], v[96:111]
    ds_read_b64_tr_b16 v[176:177], v32 offset:17920
    ds_read_b64_tr_b16 v[178:179], v32 offset:18144
    s_add_u32 m0, s67, 4096
    s_nop 0
    buffer_load_dwordx4 v11, s[16:19], s68 offen lds
    v_fma_f32 v47, v34, v62, v61
    v_fma_f32 v60, v33, v46, v68
    v_mfma_f32_32x32x16_bf16 v[112:127], v[164:167], a[12:15], v[112:127]
    ds_read_b64_tr_b16 v[180:181], v32 offset:17984
    ds_read_b64_tr_b16 v[182:183], v32 offset:18208
    buffer_load_dwordx4 v12, s[16:19], s68 offen offset:1024 lds
    v_fma_f32 v61, v33, v47, v84
    v_fma_f32 v62, -v34, v47, v60
    s_waitcnt lgkmcnt(4)
    v_mfma_f32_32x32x16_bf16 v[96:111], v[168:171], a[16:19], v[96:111]
    ds_read_b64_tr_b16 v[160:161], v32 offset:21504
    ds_read_b64_tr_b16 v[162:163], v32 offset:21728
    buffer_load_dwordx4 v13, s[16:19], s68 offen offset:2048 lds
    v_fma_f32 v63, v34, v46, v61
    v_fma_f32 v60, v33, v62, v69
    v_mfma_f32_32x32x16_bf16 v[112:127], v[172:175], a[16:19], v[112:127]
    ds_read_b64_tr_b16 v[164:165], v32 offset:21568
    ds_read_b64_tr_b16 v[166:167], v32 offset:21792
    s_add_u32 s68, s100, 12
    s_and_b32 s68, s68, 15
    s_mul_i32 s68, s68, 114688
    s_add_u32 m0, s67, 28672
    s_nop 0
    buffer_load_dwordx4 v7, s[16:19], s68 offen lds
    v_fma_f32 v61, v33, v63, v85
    v_fma_f32 v46, -v34, v63, v60
    s_waitcnt lgkmcnt(4)
    v_mfma_f32_32x32x16_bf16 v[96:111], v[176:179], a[20:23], v[96:111]
    ds_read_b64_tr_b16 v[168:169], v32 offset:25088
    ds_read_b64_tr_b16 v[170:171], v32 offset:25312
    v_fma_f32 v47, v34, v62, v61
    v_fma_f32 v60, v33, v46, v70
    v_fma_f32 v61, v33, v47, v86
    v_mfma_f32_32x32x16_bf16 v[112:127], v[180:183], a[20:23], v[112:127]
    ds_read_b64_tr_b16 v[172:173], v32 offset:25152
    ds_read_b64_tr_b16 v[174:175], v32 offset:25376
    v_fma_f32 v62, -v34, v47, v60
    v_fma_f32 v63, v34, v46, v61
    s_waitcnt lgkmcnt(4)
    v_mfma_f32_32x32x16_bf16 v[96:111], v[160:163], a[24:27], v[96:111]
    s_waitcnt vmcnt(8)
    s_barrier
    ds_read_b64_tr_b16 v[176:177], v31 offset:0
    ds_read_b64_tr_b16 v[178:179], v31 offset:224
    buffer_load_dwordx4 v8, s[16:19], s68 offen offset:1024 lds
    v_fma_f32 v60, v33, v62, v71
    v_fma_f32 v61, v33, v63, v87
    v_mfma_f32_32x32x16_bf16 v[112:127], v[164:167], a[24:27], v[112:127]
    ds_read_b64_tr_b16 v[180:181], v31 offset:64
    ds_read_b64_tr_b16 v[182:183], v31 offset:288
    buffer_load_dwordx4 v9, s[16:19], s68 offen offset:2048 lds
    v_fma_f32 v46, -v34, v63, v60
    v_fma_f32 v47, v34, v62, v61
    s_waitcnt lgkmcnt(4)
    v_mfma_f32_32x32x16_bf16 v[96:111], v[168:171], a[28:31], v[96:111]
    ds_read_b64_tr_b16 v[160:161], v31 offset:3584
    ds_read_b64_tr_b16 v[162:163], v31 offset:3808
    buffer_load_dwordx4 v10, s[16:19], s68 offen offset:3072 lds
    v_fma_f32 v60, v33, v46, v72
    v_fma_f32 v61, v33, v47, v88
    v_mfma_f32_32x32x16_bf16 v[112:127], v[172:175], a[28:31], v[112:127]
    ds_read_b64_tr_b16 v[164:165], v31 offset:3648
    ds_read_b64_tr_b16 v[166:167], v31 offset:3872
    s_add_u32 m0, s67, 32768
    s_nop 0
    buffer_load_dwordx4 v11, s[16:19], s68 offen lds
    v_fma_f32 v62, -v34, v47, v60
    v_fma_f32 v63, v34, v46, v61
    v_fma_f32 v60, v33, v62, v73
    s_waitcnt lgkmcnt(4)
    v_mfma_f32_32x32x16_bf16 v[96:111], v[176:179], a[32:35], v[96:111]
    ds_read_b64_tr_b16 v[168:169], v31 offset:7168
    ds_read_b64_tr_b16 v[170:171], v31 offset:7392
    buffer_load_dwordx4 v12, s[16:19], s68 offen offset:1024 lds
    v_fma_f32 v61, v33, v63, v89
    v_fma_f32 v46, -v34, v63, v60
    v_mfma_f32_32x32x16_bf16 v[112:127], v[180:183], a[32:35], v[112:127]
    ds_read_b64_tr_b16 v[172:173], v31 offset:7232
    ds_read_b64_tr_b16 v[174:175], v31 offset:7456
    buffer_load_dwordx4 v13, s[16:19], s68 offen offset:2048 lds
    v_fma_f32 v47, v34, v62, v61
    v_fma_f32 v60, v33, v46, v74
    s_waitcnt lgkmcnt(4)
    v_mfma_f32_32x32x16_bf16 v[96:111], v[160:163], a[36:39], v[96:111]
    ds_read_b64_tr_b16 v[176:177], v31 offset:10752
    ds_read_b64_tr_b16 v[178:179], v31 offset:10976
    s_lshl_b32 s68, s44, 4
    s_add_u32 m0, s66, 102400
    s_nop 0
    buffer_load_dwordx4 v2, s[20:23], s68 offen lds
    v_fma_f32 v61, v33, v47, v90
    v_fma_f32 v62, -v34, v47, v60
    v_mfma_f32_32x32x16_bf16 v[112:127], v[164:167], a[36:39], v[112:127]
    ds_read_b64_tr_b16 v[180:181], v31 offset:10816
    ds_read_b64_tr_b16 v[182:183], v31 offset:11040
    v_fma_f32 v63, v34, v46, v61
    v_fma_f32 v60, v33, v62, v75
    s_waitcnt lgkmcnt(4)
    v_mfma_f32_32x32x16_bf16 v[96:111], v[168:171], a[40:43], v[96:111]
    ds_read_b64_tr_b16 v[160:161], v31 offset:14336
    ds_read_b64_tr_b16 v[162:163], v31 offset:14560
    buffer_load_dwordx4 v3, s[20:23], s68 offen offset:1024 lds
    v_fma_f32 v61, v33, v63, v91
    v_fma_f32 v46, -v34, v63, v60
    v_fma_f32 v47, v34, v62, v61
    v_mfma_f32_32x32x16_bf16 v[112:127], v[172:175], a[40:43], v[112:127]
    ds_read_b64_tr_b16 v[164:165], v31 offset:14400
    ds_read_b64_tr_b16 v[166:167], v31 offset:14624
    buffer_load_dwordx4 v4, s[20:23], s68 offen offset:2048 lds
    v_fma_f32 v60, v33, v46, v76
    v_fma_f32 v61, v33, v47, v92
    s_waitcnt lgkmcnt(4)
    v_mfma_f32_32x32x16_bf16 v[96:111], v[176:179], a[44:47], v[96:111]
    ds_read_b64_tr_b16 v[168:169], v31 offset:17920
    ds_read_b64_tr_b16 v[170:171], v31 offset:18144
    buffer_load_dwordx4 v5, s[20:23], s68 offen offset:3072 lds
    v_fma_f32 v62, -v34, v47, v60
    v_fma_f32 v63, v34, v46, v61
    v_mfma_f32_32x32x16_bf16 v[112:127], v[180:183], a[44:47], v[112:127]
    ds_read_b64_tr_b16 v[172:173], v31 offset:17984
    ds_read_b64_tr_b16 v[174:175], v31 offset:18208
    v_fma_f32 v60, v33, v62, v77
    v_fma_f32 v61, v33, v63, v93
    s_waitcnt lgkmcnt(4)
    v_mfma_f32_32x32x16_bf16 v[96:111], v[160:163], a[48:51], v[96:111]
    ds_read_b64_tr_b16 v[176:177], v31 offset:21504
    ds_read_b64_tr_b16 v[178:179], v31 offset:21728
    s_lshl_b32 s68, s45, 4
    s_add_u32 m0, s66, 57344
    s_nop 0
    buffer_load_dwordx4 v2, s[20:23], s68 offen lds
    v_fma_f32 v46, -v34, v63, v60
    v_fma_f32 v47, v34, v62, v61
    v_mfma_f32_32x32x16_bf16 v[112:127], v[164:167], a[48:51], v[112:127]
    ds_read_b64_tr_b16 v[180:181], v31 offset:21568
    ds_read_b64_tr_b16 v[182:183], v31 offset:21792
    v_fma_f32 v60, v33, v46, v78
    v_fma_f32 v61, v33, v47, v94
    v_fma_f32 v62, -v34, v47, v60
    s_waitcnt lgkmcnt(4)
    v_mfma_f32_32x32x16_bf16 v[96:111], v[168:171], a[52:55], v[96:111]
    ds_read_b64_tr_b16 v[160:161], v31 offset:25088
    ds_read_b64_tr_b16 v[162:163], v31 offset:25312
    buffer_load_dwordx4 v3, s[20:23], s68 offen offset:1024 lds
    v_fma_f32 v63, v34, v46, v61
    v_fma_f32 v60, v33, v62, v79
    v_mfma_f32_32x32x16_bf16 v[112:127], v[172:175], a[52:55], v[112:127]
    ds_read_b64_tr_b16 v[164:165], v31 offset:25152
    ds_read_b64_tr_b16 v[166:167], v31 offset:25376
    buffer_load_dwordx4 v4, s[20:23], s68 offen offset:2048 lds
    v_fma_f32 v61, v33, v63, v95
    v_fma_f32 v46, -v34, v63, v60
    s_waitcnt lgkmcnt(4)
    v_mfma_f32_32x32x16_bf16 v[96:111], v[176:179], a[56:59], v[96:111]
    s_waitcnt vmcnt(14)
    s_barrier
    ds_read_b64_tr_b16 v[168:169], v30 offset:0
    ds_read_b64_tr_b16 v[170:171], v30 offset:224
    buffer_load_dwordx4 v5, s[20:23], s68 offen offset:3072 lds
    v_fma_f32 v47, v34, v62, v61
    v_lshlrev_b32 v59, 3, v0
    v_mfma_f32_32x32x16_bf16 v[112:127], v[180:183], a[56:59], v[112:127]
    ds_read_b64_tr_b16 v[172:173], v30 offset:64
    ds_read_b64_tr_b16 v[174:175], v30 offset:288
    v_add_u32 v59, 151552, v59
    ds_write_b64 v59, v[46:47] offset:1792
    s_waitcnt lgkmcnt(5)
    v_mfma_f32_32x32x16_bf16 v[96:111], v[160:163], a[60:63], v[96:111]
    ds_read_b64_tr_b16 v[176:177], v30 offset:3584
    ds_read_b64_tr_b16 v[178:179], v30 offset:3808
    s_waitcnt lgkmcnt(2)
    s_barrier
    ds_read_b64 v[192:193], v59 offset:0
    ds_read_b64 v[194:195], v59 offset:256
    v_mfma_f32_32x32x16_bf16 v[112:127], v[164:167], a[60:63], v[112:127]
    ds_read_b64_tr_b16 v[180:181], v30 offset:3648
    ds_read_b64_tr_b16 v[182:183], v30 offset:3872
    ds_read_b64 v[196:197], v59 offset:512
    ds_read_b64 v[198:199], v59 offset:768
    v_mfma_f32_32x32x16_bf16 v[96:111], v[168:171], a[64:67], v[96:111]
    ds_read_b64_tr_b16 v[160:161], v30 offset:7168
    ds_read_b64_tr_b16 v[162:163], v30 offset:7392
    ds_read_b64 v[200:201], v59 offset:1024
    ds_read_b64 v[202:203], v59 offset:1280
    v_mfma_f32_32x32x16_bf16 v[112:127], v[172:175], a[64:67], v[112:127]
    ds_read_b64_tr_b16 v[164:165], v30 offset:7232
    ds_read_b64_tr_b16 v[166:167], v30 offset:7456
    ds_read_b64 v[204:205], v59 offset:1536
    s_waitcnt lgkmcnt(0)
    v_fma_f32 v60, v35, v192, v194
    v_mfma_f32_32x32x16_bf16 v[96:111], v[176:179], a[68:71], v[96:111]
    ds_read_b64_tr_b16 v[168:169], v30 offset:10752
    ds_read_b64_tr_b16 v[170:171], v30 offset:10976
    s_waitcnt vmcnt(6)
    ds_read_b64_tr_b16 a[128:129], v14 offset:45056
    ds_read_b64_tr_b16 a[130:131], v14 offset:46080
    v_fma_f32 v61, v35, v193, v195
    v_fma_f32 v206, -v36, v193, v60
    v_mfma_f32_32x32x16_bf16 v[112:127], v[180:183], a[68:71], v[112:127]
    ds_read_b64_tr_b16 v[172:173], v30 offset:10816
    ds_read_b64_tr_b16 v[174:175], v30 offset:11040
    ds_read_b64_tr_b16 a[132:133], v15 offset:45056
    ds_read_b64_tr_b16 a[134:135], v15 offset:46080
    v_fma_f32 v207, v36, v192, v61
    v_fma_f32 v60, v35, v206, v196
    v_fma_f32 v61, v35, v207, v197
    v_mfma_f32_32x32x16_bf16 v[96:111], v[160:163], a[72:75], v[96:111]
    ds_read_b64_tr_b16 v[176:177], v30 offset:14336
    ds_read_b64_tr_b16 v[178:179], v30 offset:14560
    s_waitcnt lgkmcnt(2)
    s_lshl_b32 s68, s46, 4
    s_add_u32 m0, s66, 102400
    s_nop 0
    buffer_load_dwordx4 v2, s[20:23], s68 offen lds
    v_fma_f32 v208, -v36, v207, v60
    v_fma_f32 v209, v36, v206, v61
    v_mfma_f32_32x32x16_bf16 v[112:127], v[164:167], a[72:75], v[112:127]
    ds_read_b64_tr_b16 v[180:181], v30 offset:14400
    ds_read_b64_tr_b16 v[182:183], v30 offset:14624
    buffer_load_dwordx4 v3, s[20:23], s68 offen offset:1024 lds
    v_fma_f32 v60, v35, v208, v198
    v_fma_f32 v61, v35, v209, v199
    v_mfma_f32_32x32x16_bf16 v[96:111], v[168:171], a[76:79], v[96:111]
    ds_read_b64_tr_b16 v[160:161], v30 offset:17920
    ds_read_b64_tr_b16 v[162:163], v30 offset:18144
    v_fma_f32 v206, -v36, v209, v60
    v_fma_f32 v207, v36, v208, v61
    v_mfma_f32_32x32x16_bf16 v[112:127], v[172:175], a[76:79], v[112:127]
    ds_read_b64_tr_b16 v[164:165], v30 offset:17984
    ds_read_b64_tr_b16 v[166:167], v30 offset:18208
    v_fma_f32 v60, v35, v206, v200
    v_fma_f32 v61, v35, v207, v201
    s_waitcnt lgkmcnt(4)
    v_mfma_f32_32x32x16_bf16 v[96:111], v[176:179], a[80:83], v[96:111]
    ds_read_b64_tr_b16 v[168:169], v30 offset:21504
    ds_read_b64_tr_b16 v[170:171], v30 offset:21728
    s_waitcnt vmcnt(6)
    ds_read_b64_tr_b16 a[136:137], v14 offset:47104
    ds_read_b64_tr_b16 a[138:139], v14 offset:48128
    v_fma_f32 v208, -v36, v207, v60
    v_fma_f32 v209, v36, v206, v61
    v_fma_f32 v60, v35, v208, v202
    v_mfma_f32_32x32x16_bf16 v[112:127], v[180:183], a[80:83], v[112:127]
    ds_read_b64_tr_b16 v[172:173], v30 offset:21568
    ds_read_b64_tr_b16 v[174:175], v30 offset:21792
    ds_read_b64_tr_b16 a[140:141], v15 offset:47104
    ds_read_b64_tr_b16 a[142:143], v15 offset:48128
    v_fma_f32 v61, v35, v209, v203
    v_fma_f32 v206, -v36, v209, v60
    s_waitcnt lgkmcnt(8)
    v_mfma_f32_32x32x16_bf16 v[96:111], v[160:163], a[84:87], v[96:111]
    ds_read_b64_tr_b16 v[176:177], v30 offset:25088
    ds_read_b64_tr_b16 v[178:179], v30 offset:25312
    s_waitcnt lgkmcnt(2)
    buffer_load_dwordx4 v4, s[20:23], s68 offen offset:2048 lds
    buffer_load_dwordx4 v5, s[20:23], s68 offen offset:3072 lds
    v_fma_f32 v207, v36, v208, v61
    v_fma_f32 v60, v35, v206, v204
    v_mfma_f32_32x32x16_bf16 v[112:127], v[164:167], a[84:87], v[112:127]
    ds_read_b64_tr_b16 v[180:181], v30 offset:25152
    ds_read_b64_tr_b16 v[182:183], v30 offset:25376
    v_fma_f32 v61, v35, v207, v205
    v_fma_f32 v48, -v36, v207, v60
    v_mfma_f32_32x32x16_bf16 v[96:111], v[168:171], a[88:91], v[96:111]
    s_barrier
    ds_read_b64_tr_b16 v[160:161], v30 offset:28672
    ds_read_b64_tr_b16 v[162:163], v30 offset:28896
    v_fma_f32 v45, v36, v206, v61
    v_fma_f32 v60, v35, v48, v46
    v_mfma_f32_32x32x16_bf16 v[112:127], v[172:175], a[88:91], v[112:127]
    ds_read_b64_tr_b16 v[164:165], v30 offset:28736
    ds_read_b64_tr_b16 v[166:167], v30 offset:28960
    v_fma_f32 v61, v35, v45, v47
    v_fma_f32 v192, -v36, v45, v60
    v_fma_f32 v194, v36, v48, v61
    s_waitcnt lgkmcnt(4)
    v_mfma_f32_32x32x16_bf16 v[96:111], v[176:179], a[92:95], v[96:111]
    ds_read_b64_tr_b16 v[168:169], v30 offset:32256
    ds_read_b64_tr_b16 v[170:171], v30 offset:32480
    s_waitcnt vmcnt(6)
    ds_read_b64_tr_b16 a[144:145], v14 offset:0
    ds_read_b64_tr_b16 a[146:147], v14 offset:1024
    v_cmp_ne_u32 vcc, 0, v49
    s_nop 4
    s_cbranch_vccz L_nonce_slow
L_nonce_ok:
    v_readfirstlane_b32 s63, v49
    v_mov_b32 v193, v49
    v_mov_b32 v195, v49
    v_lshlrev_b32 v60, 4, v50
    s_cmp_lg_u32 s60, 3
    s_cbranch_scc1 L_noE
    s_lshl_b32 s72, s58, 9
    s_add_u32 s72, s72, s87
    s_mov_b32 exec_lo, 0
    buffer_store_dwordx4 v[192:195], v60, s[32:35], s72 offen sc1
    s_mov_b64 exec, -1
    s_nop 1
L_noE:
    v_mfma_f32_32x32x16_bf16 v[112:127], v[180:183], a[92:95], v[112:127]
    ds_read_b64_tr_b16 v[172:173], v30 offset:32320
    ds_read_b64_tr_b16 v[174:175], v30 offset:32544
    ds_read_b64_tr_b16 a[148:149], v15 offset:0
    ds_read_b64_tr_b16 a[150:151], v15 offset:1024
    v_lshrrev_b32_e64 v10, 4, v1
    s_waitcnt lgkmcnt(8)
    v_mfma_f32_32x32x16_bf16 v[96:111], v[160:163], a[96:99], v[96:111]
    ds_read_b64_tr_b16 v[176:177], v30 offset:35840
    ds_read_b64_tr_b16 v[178:179], v30 offset:36064
    s_waitcnt lgkmcnt(2)
    s_lshl_b32 s68, s47, 4
    s_add_u32 m0, s66, 57344
    s_nop 0
    buffer_load_dwordx4 v2, s[20:23], s68 offen lds
    v_and_b32 v11, 15, v1
    v_xor_b32_e64 v11, v11, v10
    v_mfma_f32_32x32x16_bf16 v[112:127], v[164:167], a[96:99], v[112:127]
    ds_read_b64_tr_b16 v[180:181], v30 offset:35904
    ds_read_b64_tr_b16 v[182:183], v30 offset:36128
    buffer_load_dwordx4 v3, s[20:23], s68 offen offset:1024 lds
    v_lshlrev_b32_e64 v11, 4, v11
    v_mfma_f32_32x32x16_bf16 v[96:111], v[168:171], a[100:103], v[96:111]
    ds_read_b64_tr_b16 v[160:161], v30 offset:39424
    ds_read_b64_tr_b16 v[162:163], v30 offset:39648
    v_lshl_add_u32 v11, v10, 10, v11
    s_lshl_b32 s72, s62, 16
    s_lshl_b32 s73, s60, 8
    s_add_u32 s72, s72, s73
    v_add_u32 v6, s72, v11
    v_mfma_f32_32x32x16_bf16 v[112:127], v[172:175], a[100:103], v[112:127]
    ds_read_b64_tr_b16 v[164:165], v30 offset:39488
    ds_read_b64_tr_b16 v[166:167], v30 offset:39712
    s_waitcnt lgkmcnt(4)
    v_mfma_f32_32x32x16_bf16 v[96:111], v[176:179], a[104:107], v[96:111]
    ds_read_b64_tr_b16 v[168:169], v30 offset:43008
    ds_read_b64_tr_b16 v[170:171], v30 offset:43232
    s_waitcnt vmcnt(6)
    ds_read_b64_tr_b16 a[152:153], v14 offset:2048
    ds_read_b64_tr_b16 a[154:155], v14 offset:3072
    v_xor_b32_e64 v11, 64, v6
    v_mfma_f32_32x32x16_bf16 v[112:127], v[180:183], a[104:107], v[112:127]
    ds_read_b64_tr_b16 v[172:173], v30 offset:43072
    ds_read_b64_tr_b16 v[174:175], v30 offset:43296
    ds_read_b64_tr_b16 a[156:157], v15 offset:2048
    ds_read_b64_tr_b16 a[158:159], v15 offset:3072
    v_add_u32 v7, 3072, v11
    s_waitcnt lgkmcnt(8)
    v_mfma_f32_32x32x16_bf16 v[96:111], v[160:163], a[108:111], v[96:111]
    ds_read_b64_tr_b16 v[176:177], v30 offset:46592
    ds_read_b64_tr_b16 v[178:179], v30 offset:46816
    s_waitcnt lgkmcnt(2)
    buffer_load_dwordx4 v4, s[20:23], s68 offen offset:2048 lds
    buffer_load_dwordx4 v5, s[20:23], s68 offen offset:3072 lds
    v_xor_b32 v11, 128, v6
    v_add_u32 v8, 6144, v11
    v_mfma_f32_32x32x16_bf16 v[112:127], v[164:167], a[108:111], v[112:127]
    ds_read_b64_tr_b16 v[180:181], v30 offset:46656
    ds_read_b64_tr_b16 v[182:183], v30 offset:46880
    v_xor_b32 v11, 192, v6
    v_mfma_f32_32x32x16_bf16 v[96:111], v[168:171], a[112:115], v[96:111]
    ds_read_b64_tr_b16 v[160:161], v30 offset:50176
    ds_read_b64_tr_b16 v[162:163], v30 offset:50400
    v_add_u32 v9, 9216, v11
    v_add_u32_e64 v12, s99, v16
    v_mfma_f32_32x32x16_bf16 v[112:127], v[172:175], a[112:115], v[112:127]
    ds_read_b64_tr_b16 v[164:165], v30 offset:50240
    ds_read_b64_tr_b16 v[166:167], v30 offset:50464
    v_add_u32 v13, s99, v17
    s_waitcnt lgkmcnt(4)
    v_mfma_f32_32x32x16_bf16 v[96:111], v[176:179], a[116:119], v[96:111]
    ds_read_b64_tr_b16 v[168:169], v30 offset:53760
    ds_read_b64_tr_b16 v[170:171], v30 offset:53984
    s_waitcnt vmcnt(6)
    ds_read_b64_tr_b16 a[160:161], v14 offset:45056
    ds_read_b64_tr_b16 a[162:163], v14 offset:46080
    v_lshlrev_b32 v232, 4, v0
    v_add_u32 v233, 4096, v232
    v_mfma_f32_32x32x16_bf16 v[112:127], v[180:183], a[116:119], v[112:127]
    ds_read_b64_tr_b16 v[172:173], v30 offset:53824
    ds_read_b64_tr_b16 v[174:175], v30 offset:54048
    ds_read_b64_tr_b16 a[164:165], v15 offset:45056
    ds_read_b64_tr_b16 a[166:167], v15 offset:46080
    v_mov_b32 v224, 0
    s_waitcnt lgkmcnt(8)
    v_mfma_f32_32x32x16_bf16 v[96:111], v[160:163], a[120:123], v[96:111]
    ds_read_b64_tr_b16 v[176:177], v32 offset:128
    ds_read_b64_tr_b16 v[178:179], v32 offset:352
    s_waitcnt lgkmcnt(2)
    s_lshl_b32 s68, s48, 4
    s_add_u32 m0, s66, 102400
    s_nop 0
    buffer_load_dwordx4 v2, s[20:23], s68 offen lds
    v_mov_b32 v225, 0
    v_mov_b32_e64 v226, 0
    v_mfma_f32_32x32x16_bf16 v[112:127], v[164:167], a[120:123], v[112:127]
    ds_read_b64_tr_b16 v[180:181], v32 offset:192
    ds_read_b64_tr_b16 v[182:183], v32 offset:416
    buffer_load_dwordx4 v3, s[20:23], s68 offen offset:1024 lds
    v_mov_b32_e64 v227, 0
    v_mfma_f32_32x32x16_bf16 v[96:111], v[168:171], a[124:127], v[96:111]
    ds_read_b64_tr_b16 v[160:161], v32 offset:3712
    ds_read_b64_tr_b16 v[162:163], v32 offset:3936
    v_mov_b32 v228, 0
    v_mov_b32 v229, 0
    v_mfma_f32_32x32x16_bf16 v[112:127], v[172:175], a[124:127], v[112:127]
    ds_read_b64_tr_b16 v[164:165], v32 offset:3776
    ds_read_b64_tr_b16 v[166:167], v32 offset:4000
    v_mov_b32_e64 v230, 0
    s_waitcnt lgkmcnt(4)
    v_mfma_f32_32x32x16_bf16 v[128:143], v[176:179], a[0:3], v[128:143]
    ds_read_b64_tr_b16 v[168:169], v32 offset:7296
    ds_read_b64_tr_b16 v[170:171], v32 offset:7520
    s_waitcnt vmcnt(6)
    ds_read_b64_tr_b16 a[168:169], v14 offset:47104
    ds_read_b64_tr_b16 a[170:171], v14 offset:48128
    v_mov_b32_e64 v231, 0
    v_bfe_u32 v60, v50, 1, 2
    v_mfma_f32_32x32x16_bf16 v[144:159], v[180:183], a[0:3], v[144:159]
    ds_read_b64_tr_b16 v[172:173], v32 offset:7360
    ds_read_b64_tr_b16 v[174:175], v32 offset:7584
    ds_read_b64_tr_b16 a[172:173], v15 offset:47104
    ds_read_b64_tr_b16 a[174:175], v15 offset:48128
    v_lshlrev_b32 v61, 1, v51
    s_waitcnt lgkmcnt(8)
    v_mfma_f32_32x32x16_bf16 v[128:143], v[160:163], a[4:7], v[128:143]
    ds_read_b64_tr_b16 v[176:177], v32 offset:10880
    ds_read_b64_tr_b16 v[178:179], v32 offset:11104
    s_waitcnt lgkmcnt(2)
    buffer_load_dwordx4 v4, s[20:23], s68 offen offset:2048 lds
    buffer_load_dwordx4 v5, s[20:23], s68 offen offset:3072 lds
    v_xor_b32 v60, v60, v61
    v_lshlrev_b32_e64 v60, 4, v60
    v_mfma_f32_32x32x16_bf16 v[144:159], v[164:167], a[4:7], v[144:159]
    ds_read_b64_tr_b16 v[180:181], v32 offset:10944
    ds_read_b64_tr_b16 v[182:183], v32 offset:11168
    v_lshl_add_u32 v60, v50, 6, v60
    v_mfma_f32_32x32x16_bf16 v[128:143], v[168:171], a[8:11], v[128:143]
    ds_read_b64_tr_b16 v[160:161], v32 offset:14464
    ds_read_b64_tr_b16 v[162:163], v32 offset:14688
    s_lshl_b32 s101, s60, 11
    s_add_u32 s101, s101, 155648
    v_max_f32 v96, 0, v96
    v_mfma_f32_32x32x16_bf16 v[144:159], v[172:175], a[8:11], v[144:159]
    ds_read_b64_tr_b16 v[164:165], v32 offset:14528
    ds_read_b64_tr_b16 v[166:167], v32 offset:14752
    v_add_u32 v58, s101, v60
    v_max_f32 v97, 0, v97
    v_max_f32 v98, 0, v98
    s_waitcnt lgkmcnt(4)
    v_mfma_f32_32x32x16_bf16 v[128:143], v[176:179], a[12:15], v[128:143]
    ds_read_b64_tr_b16 v[168:169], v32 offset:18048
    ds_read_b64_tr_b16 v[170:171], v32 offset:18272
    s_waitcnt vmcnt(6)
    ds_read_b64_tr_b16 a[176:177], v14 offset:0
    ds_read_b64_tr_b16 a[178:179], v14 offset:1024
    v_xor_b32 v56, 16, v58
    v_bfe_u32 v60, v1, 2, 2
    v_max_f32_e64 v99, 0, v99
    v_mfma_f32_32x32x16_bf16 v[144:159], v[180:183], a[12:15], v[144:159]
    ds_read_b64_tr_b16 v[172:173], v32 offset:18112
    ds_read_b64_tr_b16 v[174:175], v32 offset:18336
    ds_read_b64_tr_b16 a[180:181], v15 offset:0
    ds_read_b64_tr_b16 a[182:183], v15 offset:1024
    v_lshl_add_u32 v61, v51, 3, v60
    v_max_f32 v100, 0, v100
    v_max_f32_e64 v101, 0, v101
    s_waitcnt lgkmcnt(8)
    v_mfma_f32_32x32x16_bf16 v[128:143], v[160:163], a[16:19], v[128:143]
    ds_read_b64_tr_b16 v[176:177], v32 offset:21632
    ds_read_b64_tr_b16 v[178:179], v32 offset:21856
    s_waitcnt lgkmcnt(2)
    s_lshl_b32 s68, s49, 4
    s_add_u32 m0, s66, 57344
    s_nop 0
    buffer_load_dwordx4 v2, s[20:23], s68 offen lds
    v_lshlrev_b32 v61, 6, v61
    v_and_b32 v62, 1, v1
    v_max_f32 v102, 0, v102
    v_mfma_f32_32x32x16_bf16 v[144:159], v[164:167], a[16:19], v[144:159]
    ds_read_b64_tr_b16 v[180:181], v32 offset:21696
    ds_read_b64_tr_b16 v[182:183], v32 offset:21920
    buffer_load_dwordx4 v3, s[20:23], s68 offen offset:1024 lds
    v_lshlrev_b32 v62, 1, v62
    v_max_f32 v103, 0, v103
    v_mul_f32_e64 v96, v96, v96
    v_mfma_f32_32x32x16_bf16 v[128:143], v[168:171], a[20:23], v[128:143]
    ds_read_b64_tr_b16 v[160:161], v32 offset:25216
    ds_read_b64_tr_b16 v[162:163], v32 offset:25440
    v_bfe_u32 v63, v1, 4, 1
    v_or_b32 v62, v62, v63
    v_mul_f32 v97, v97, v97
    v_mfma_f32_32x32x16_bf16 v[144:159], v[172:175], a[20:23], v[144:159]
    ds_read_b64_tr_b16 v[164:165], v32 offset:25280
    ds_read_b64_tr_b16 v[166:167], v32 offset:25504
    v_lshrrev_b32 v60, 1, v60
    v_mul_f32 v98, v98, v98
    v_mul_f32 v99, v99, v99
    s_waitcnt lgkmcnt(4)
    v_mfma_f32_32x32x16_bf16 v[128:143], v[176:179], a[24:27], v[128:143]
    ds_read_b64_tr_b16 v[168:169], v31 offset:128
    ds_read_b64_tr_b16 v[170:171], v31 offset:352
    s_waitcnt vmcnt(6)
    ds_read_b64_tr_b16 a[184:185], v14 offset:2048
    ds_read_b64_tr_b16 a[186:187], v14 offset:3072
    v_xor_b32 v62, v62, v60
    v_lshl_add_u32 v61, v62, 4, v61
    v_mul_f32_e64 v100, v100, v100
    v_mfma_f32_32x32x16_bf16 v[144:159], v[180:183], a[24:27], v[144:159]
    ds_read_b64_tr_b16 v[172:173], v31 offset:192
    ds_read_b64_tr_b16 v[174:175], v31 offset:416
    ds_read_b64_tr_b16 a[188:189], v15 offset:2048
    ds_read_b64_tr_b16 a[190:191], v15 offset:3072
    v_bfe_u32 v62, v1, 1, 1
    v_mul_f32 v101, v101, v101
    v_mul_f32_e64 v102, v102, v102
    s_waitcnt lgkmcnt(8)
    v_mfma_f32_32x32x16_bf16 v[128:143], v[160:163], a[28:31], v[128:143]
    ds_read_b64_tr_b16 v[176:177], v31 offset:3712
    ds_read_b64_tr_b16 v[178:179], v31 offset:3936
    s_waitcnt lgkmcnt(2)
    buffer_load_dwordx4 v4, s[20:23], s68 offen offset:2048 lds
    buffer_load_dwordx4 v5, s[20:23], s68 offen offset:3072 lds
    v_lshl_add_u32 v61, v62, 3, v61
    v_add_u32 v53, s101, v61
    v_mul_f32_e64 v103, v103, v103
    v_mfma_f32_32x32x16_bf16 v[144:159], v[164:167], a[28:31], v[144:159]
    ds_read_b64_tr_b16 v[180:181], v31 offset:3776
    ds_read_b64_tr_b16 v[182:183], v31 offset:4000
    v_xor_b32_e64 v57, 32, v53
    v_cvt_pk_bf16_f32 v208, v96, v97
    v_cvt_pk_bf16_f32 v209, v98, v99
    v_mfma_f32_32x32x16_bf16 v[128:143], v[168:171], a[32:35], v[128:143]
    ds_read_b64_tr_b16 v[160:161], v31 offset:7296
    ds_read_b64_tr_b16 v[162:163], v31 offset:7520
    v_cvt_pk_bf16_f32 v210, v100, v101
    v_mfma_f32_32x32x16_bf16 v[144:159], v[172:175], a[32:35], v[144:159]
    ds_read_b64_tr_b16 v[164:165], v31 offset:7360
    ds_read_b64_tr_b16 v[166:167], v31 offset:7584
    v_cvt_pk_bf16_f32 v211, v102, v103
    buffer_store_dwordx4 v[208:211], v54, s[32:35], s82 offen sc1
    s_waitcnt lgkmcnt(4)
    v_mfma_f32_32x32x16_bf16 v[128:143], v[176:179], a[36:39], v[128:143]
    ds_read_b64_tr_b16 v[168:169], v31 offset:10880
    ds_read_b64_tr_b16 v[170:171], v31 offset:11104
    s_waitcnt vmcnt(7)
    ds_read_b64_tr_b16 a[192:193], v14 offset:45056
    ds_read_b64_tr_b16 a[194:195], v14 offset:46080
    v_max_f32_e64 v104, 0, v104
    v_mfma_f32_32x32x16_bf16 v[144:159], v[180:183], a[36:39], v[144:159]
    ds_read_b64_tr_b16 v[172:173], v31 offset:10944
    ds_read_b64_tr_b16 v[174:175], v31 offset:11168
    ds_read_b64_tr_b16 a[196:197], v15 offset:45056
    ds_read_b64_tr_b16 a[198:199], v15 offset:46080
    v_max_f32 v105, 0, v105
    v_max_f32_e64 v106, 0, v106
    s_waitcnt lgkmcnt(8)
    v_mfma_f32_32x32x16_bf16 v[128:143], v[160:163], a[40:43], v[128:143]
    ds_read_b64_tr_b16 v[176:177], v31 offset:14464
    ds_read_b64_tr_b16 v[178:179], v31 offset:14688
    s_waitcnt lgkmcnt(2)
    s_lshl_b32 s68, s50, 4
    s_add_u32 m0, s66, 102400
    s_nop 0
    buffer_load_dwordx4 v2, s[20:23], s68 offen lds
    v_max_f32 v107, 0, v107
    v_mfma_f32_32x32x16_bf16 v[144:159], v[164:167], a[40:43], v[144:159]
    ds_read_b64_tr_b16 v[180:181], v31 offset:14528
    ds_read_b64_tr_b16 v[182:183], v31 offset:14752
    buffer_load_dwordx4 v3, s[20:23], s68 offen offset:1024 lds
    v_max_f32 v108, 0, v108
    v_max_f32 v109, 0, v109
    v_mfma_f32_32x32x16_bf16 v[128:143], v[168:171], a[44:47], v[128:143]
    ds_read_b64_tr_b16 v[160:161], v31 offset:18048
    ds_read_b64_tr_b16 v[162:163], v31 offset:18272
    v_max_f32_e64 v110, 0, v110
    v_mfma_f32_32x32x16_bf16 v[144:159], v[172:175], a[44:47], v[144:159]
    ds_read_b64_tr_b16 v[164:165], v31 offset:18112
    ds_read_b64_tr_b16 v[166:167], v31 offset:18336
    v_max_f32 v111, 0, v111
    v_mul_f32 v104, v104, v104
    s_waitcnt lgkmcnt(4)
    v_mfma_f32_32x32x16_bf16 v[128:143], v[176:179], a[48:51], v[128:143]
    ds_read_b64_tr_b16 v[168:169], v31 offset:21632
    ds_read_b64_tr_b16 v[170:171], v31 offset:21856
    s_waitcnt vmcnt(7)
    ds_read_b64_tr_b16 a[200:201], v14 offset:47104
    ds_read_b64_tr_b16 a[202:203], v14 offset:48128
    v_mul_f32_e64 v105, v105, v105
    v_mfma_f32_32x32x16_bf16 v[144:159], v[180:183], a[48:51], v[144:159]
    ds_read_b64_tr_b16 v[172:173], v31 offset:21696
    ds_read_b64_tr_b16 v[174:175], v31 offset:21920
    ds_read_b64_tr_b16 a[204:205], v15 offset:47104
    ds_read_b64_tr_b16 a[206:207], v15 offset:48128
    v_mul_f32 v106, v106, v106
    v_mul_f32_e64 v107, v107, v107
    s_waitcnt lgkmcnt(8)
    v_mfma_f32_32x32x16_bf16 v[128:143], v[160:163], a[52:55], v[128:143]
    ds_read_b64_tr_b16 v[176:177], v31 offset:25216
    ds_read_b64_tr_b16 v[178:179], v31 offset:25440
    s_waitcnt lgkmcnt(2)
    buffer_load_dwordx4 v4, s[20:23], s68 offen offset:2048 lds
    buffer_load_dwordx4 v5, s[20:23], s68 offen offset:3072 lds
    v_mul_f32 v108, v108, v108
    v_mfma_f32_32x32x16_bf16 v[144:159], v[164:167], a[52:55], v[144:159]
    ds_read_b64_tr_b16 v[180:181], v31 offset:25280
    ds_read_b64_tr_b16 v[182:183], v31 offset:25504
    v_mul_f32 v109, v109, v109
    v_mul_f32 v110, v110, v110
    v_mfma_f32_32x32x16_bf16 v[128:143], v[168:171], a[56:59], v[128:143]
    ds_read_b64_tr_b16 v[160:161], v30 offset:128
    ds_read_b64_tr_b16 v[162:163], v30 offset:352
    v_mul_f32_e64 v111, v111, v111
    v_mfma_f32_32x32x16_bf16 v[144:159], v[172:175], a[56:59], v[144:159]
    ds_read_b64_tr_b16 v[164:165], v30 offset:192
    ds_read_b64_tr_b16 v[166:167], v30 offset:416
    v_cvt_pk_bf16_f32 v212, v104, v105
    v_cvt_pk_bf16_f32 v213, v106, v107
    s_waitcnt lgkmcnt(4)
    v_mfma_f32_32x32x16_bf16 v[128:143], v[176:179], a[60:63], v[128:143]
    ds_read_b64_tr_b16 v[168:169], v30 offset:3712
    ds_read_b64_tr_b16 v[170:171], v30 offset:3936
    s_waitcnt vmcnt(7)
    ds_read_b64_tr_b16 a[208:209], v14 offset:0
    ds_read_b64_tr_b16 a[210:211], v14 offset:1024
    v_cvt_pk_bf16_f32 v214, v108, v109
    v_mfma_f32_32x32x16_bf16 v[144:159], v[180:183], a[60:63], v[144:159]
    ds_read_b64_tr_b16 v[172:173], v30 offset:3776
    ds_read_b64_tr_b16 v[174:175], v30 offset:4000
    ds_read_b64_tr_b16 a[212:213], v15 offset:0
    ds_read_b64_tr_b16 a[214:215], v15 offset:1024
    v_cvt_pk_bf16_f32 v215, v110, v111
    buffer_store_dwordx4 v[212:215], v54, s[32:35], s82 offen offset:1024 sc1
    s_waitcnt lgkmcnt(8)
    v_mfma_f32_32x32x16_bf16 v[128:143], v[160:163], a[64:67], v[128:143]
    ds_read_b64_tr_b16 v[176:177], v30 offset:7296
    ds_read_b64_tr_b16 v[178:179], v30 offset:7520
    s_waitcnt lgkmcnt(2)
    s_lshl_b32 s68, s51, 4
    s_add_u32 m0, s66, 57344
    s_nop 0
    buffer_load_dwordx4 v2, s[20:23], s68 offen lds
    v_max_f32_e64 v112, 0, v112
    v_mfma_f32_32x32x16_bf16 v[144:159], v[164:167], a[64:67], v[144:159]
    ds_read_b64_tr_b16 v[180:181], v30 offset:7360
    ds_read_b64_tr_b16 v[182:183], v30 offset:7584
    buffer_load_dwordx4 v3, s[20:23], s68 offen offset:1024 lds
    v_max_f32 v113, 0, v113
    v_max_f32 v114, 0, v114
    v_mfma_f32_32x32x16_bf16 v[128:143], v[168:171], a[68:71], v[128:143]
    ds_read_b64_tr_b16 v[160:161], v30 offset:10880
    ds_read_b64_tr_b16 v[162:163], v30 offset:11104
    v_max_f32_e64 v115, 0, v115
    v_mfma_f32_32x32x16_bf16 v[144:159], v[172:175], a[68:71], v[144:159]
    ds_read_b64_tr_b16 v[164:165], v30 offset:10944
    ds_read_b64_tr_b16 v[166:167], v30 offset:11168
    v_max_f32 v116, 0, v116
    v_max_f32 v117, 0, v117
    s_waitcnt lgkmcnt(4)
    v_mfma_f32_32x32x16_bf16 v[128:143], v[176:179], a[72:75], v[128:143]
    ds_read_b64_tr_b16 v[168:169], v30 offset:14464
    ds_read_b64_tr_b16 v[170:171], v30 offset:14688
    s_waitcnt vmcnt(8)
    ds_read_b64_tr_b16 a[216:217], v14 offset:2048
    ds_read_b64_tr_b16 a[218:219], v14 offset:3072
    v_max_f32_e64 v118, 0, v118
    v_mfma_f32_32x32x16_bf16 v[144:159], v[180:183], a[72:75], v[144:159]
    ds_read_b64_tr_b16 v[172:173], v30 offset:14528
    ds_read_b64_tr_b16 v[174:175], v30 offset:14752
    ds_read_b64_tr_b16 a[220:221], v15 offset:2048
    ds_read_b64_tr_b16 a[222:223], v15 offset:3072
    v_max_f32 v119, 0, v119
    v_mul_f32_e64 v112, v112, v112
    s_waitcnt lgkmcnt(8)
    v_mfma_f32_32x32x16_bf16 v[128:143], v[160:163], a[76:79], v[128:143]
    ds_read_b64_tr_b16 v[176:177], v30 offset:18048
    ds_read_b64_tr_b16 v[178:179], v30 offset:18272
    s_waitcnt lgkmcnt(2)
    buffer_load_dwordx4 v4, s[20:23], s68 offen offset:2048 lds
    buffer_load_dwordx4 v5, s[20:23], s68 offen offset:3072 lds
    v_mul_f32 v113, v113, v113
    v_mfma_f32_32x32x16_bf16 v[144:159], v[164:167], a[76:79], v[144:159]
    ds_read_b64_tr_b16 v[180:181], v30 offset:18112
    ds_read_b64_tr_b16 v[182:183], v30 offset:18336
    v_mul_f32 v114, v114, v114
    v_mul_f32 v115, v115, v115
    v_mfma_f32_32x32x16_bf16 v[128:143], v[168:171], a[80:83], v[128:143]
    ds_read_b64_tr_b16 v[160:161], v30 offset:21632
    ds_read_b64_tr_b16 v[162:163], v30 offset:21856
    v_mul_f32_e64 v116, v116, v116
    v_mfma_f32_32x32x16_bf16 v[144:159], v[172:175], a[80:83], v[144:159]
    ds_read_b64_tr_b16 v[164:165], v30 offset:21696
    ds_read_b64_tr_b16 v[166:167], v30 offset:21920
    v_mul_f32 v117, v117, v117
    v_mul_f32 v118, v118, v118
    s_waitcnt lgkmcnt(4)
    v_mfma_f32_32x32x16_bf16 v[128:143], v[176:179], a[84:87], v[128:143]
    ds_read_b64_tr_b16 v[168:169], v30 offset:25216
    ds_read_b64_tr_b16 v[170:171], v30 offset:25440
    s_waitcnt vmcnt(7)
    ds_read_b64_tr_b16 a[224:225], v14 offset:45056
    ds_read_b64_tr_b16 a[226:227], v14 offset:46080
    v_mul_f32_e64 v119, v119, v119
    v_mfma_f32_32x32x16_bf16 v[144:159], v[180:183], a[84:87], v[144:159]
    ds_read_b64_tr_b16 v[172:173], v30 offset:25280
    ds_read_b64_tr_b16 v[174:175], v30 offset:25504
    ds_read_b64_tr_b16 a[228:229], v15 offset:45056
    ds_read_b64_tr_b16 a[230:231], v15 offset:46080
    v_cvt_pk_bf16_f32 v216, v112, v113
    v_cvt_pk_bf16_f32 v217, v114, v115
    s_waitcnt lgkmcnt(8)
    v_mfma_f32_32x32x16_bf16 v[128:143], v[160:163], a[88:91], v[128:143]
    ds_read_b64_tr_b16 v[176:177], v30 offset:28800
    ds_read_b64_tr_b16 v[178:179], v30 offset:29024
    v_cvt_pk_bf16_f32 v218, v116, v117
    v_mfma_f32_32x32x16_bf16 v[144:159], v[164:167], a[88:91], v[144:159]
    ds_read_b64_tr_b16 v[180:181], v30 offset:28864
    ds_read_b64_tr_b16 v[182:183], v30 offset:29088
    v_cvt_pk_bf16_f32 v219, v118, v119
    buffer_store_dwordx4 v[216:219], v54, s[32:35], s82 offen offset:2048 sc1
    s_waitcnt lgkmcnt(6)
    v_mfma_f32_32x32x16_bf16 v[128:143], v[168:171], a[92:95], v[128:143]
    ds_read_b64_tr_b16 v[160:161], v30 offset:32384
    ds_read_b64_tr_b16 v[162:163], v30 offset:32608
    v_max_f32_e64 v120, 0, v120
    v_mfma_f32_32x32x16_bf16 v[144:159], v[172:175], a[92:95], v[144:159]
    ds_read_b64_tr_b16 v[164:165], v30 offset:32448
    ds_read_b64_tr_b16 v[166:167], v30 offset:32672
    v_max_f32 v121, 0, v121
    v_max_f32 v122, 0, v122
    s_waitcnt lgkmcnt(4)
    v_mfma_f32_32x32x16_bf16 v[128:143], v[176:179], a[96:99], v[128:143]
    ds_read_b64_tr_b16 v[168:169], v30 offset:35968
    ds_read_b64_tr_b16 v[170:171], v30 offset:36192
    s_waitcnt vmcnt(6)
    ds_read_b64_tr_b16 a[232:233], v14 offset:47104
    ds_read_b64_tr_b16 a[234:235], v14 offset:48128
    v_max_f32_e64 v123, 0, v123
    v_mfma_f32_32x32x16_bf16 v[144:159], v[180:183], a[96:99], v[144:159]
    ds_read_b64_tr_b16 v[172:173], v30 offset:36032
    ds_read_b64_tr_b16 v[174:175], v30 offset:36256
    ds_read_b64_tr_b16 a[236:237], v15 offset:47104
    ds_read_b64_tr_b16 a[238:239], v15 offset:48128
    v_max_f32 v124, 0, v124
    v_max_f32_e64 v125, 0, v125
    s_waitcnt lgkmcnt(8)
    v_mfma_f32_32x32x16_bf16 v[128:143], v[160:163], a[100:103], v[128:143]
    ds_read_b64_tr_b16 v[176:177], v30 offset:39552
    ds_read_b64_tr_b16 v[178:179], v30 offset:39776
    v_max_f32_e64 v126, 0, v126
    v_mfma_f32_32x32x16_bf16 v[144:159], v[164:167], a[100:103], v[144:159]
    ds_read_b64_tr_b16 v[180:181], v30 offset:39616
    ds_read_b64_tr_b16 v[182:183], v30 offset:39840
    v_max_f32 v127, 0, v127
    v_mul_f32_e64 v120, v120, v120
    s_waitcnt lgkmcnt(6)
    v_mfma_f32_32x32x16_bf16 v[128:143], v[168:171], a[104:107], v[128:143]
    ds_read_b64_tr_b16 v[160:161], v30 offset:43136
    ds_read_b64_tr_b16 v[162:163], v30 offset:43360
    v_mul_f32_e64 v121, v121, v121
    v_mfma_f32_32x32x16_bf16 v[144:159], v[172:175], a[104:107], v[144:159]
    ds_read_b64_tr_b16 v[164:165], v30 offset:43200
    ds_read_b64_tr_b16 v[166:167], v30 offset:43424
    v_mul_f32 v122, v122, v122
    v_mul_f32_e64 v123, v123, v123
    s_waitcnt lgkmcnt(4)
    v_mfma_f32_32x32x16_bf16 v[128:143], v[176:179], a[108:111], v[128:143]
    ds_read_b64_tr_b16 v[168:169], v30 offset:46720
    ds_read_b64_tr_b16 v[170:171], v30 offset:46944
    s_waitcnt vmcnt(3)
    ds_read_b64_tr_b16 a[240:241], v14 offset:0
    ds_read_b64_tr_b16 a[242:243], v14 offset:1024
    v_mul_f32 v124, v124, v124
    v_mfma_f32_32x32x16_bf16 v[144:159], v[180:183], a[108:111], v[144:159]
    ds_read_b64_tr_b16 v[172:173], v30 offset:46784
    ds_read_b64_tr_b16 v[174:175], v30 offset:47008
    ds_read_b64_tr_b16 a[244:245], v15 offset:0
    ds_read_b64_tr_b16 a[246:247], v15 offset:1024
    v_mul_f32 v125, v125, v125
    v_mul_f32 v126, v126, v126
    s_waitcnt lgkmcnt(8)
    v_mfma_f32_32x32x16_bf16 v[128:143], v[160:163], a[112:115], v[128:143]
    ds_read_b64_tr_b16 v[176:177], v30 offset:50304
    ds_read_b64_tr_b16 v[178:179], v30 offset:50528
    v_mul_f32 v127, v127, v127
    s_mov_b64 exec, s[74:75]
    buffer_load_dwordx4 v[224:227], v232, s[32:35], s87 offen sc1
    s_mov_b64 exec, s[76:77]
    buffer_load_dwordx4 v[228:231], v233, s[32:35], s87 offen sc1
    s_mov_b64 exec, -1
    v_mfma_f32_32x32x16_bf16 v[144:159], v[164:167], a[112:115], v[144:159]
    ds_read_b64_tr_b16 v[180:181], v30 offset:50368
    ds_read_b64_tr_b16 v[182:183], v30 offset:50592
    v_cvt_pk_bf16_f32 v220, v120, v121
    v_cvt_pk_bf16_f32 v221, v122, v123
    s_waitcnt lgkmcnt(6)
    v_mfma_f32_32x32x16_bf16 v[128:143], v[168:171], a[116:119], v[128:143]
    ds_read_b64_tr_b16 v[160:161], v30 offset:53888
    ds_read_b64_tr_b16 v[162:163], v30 offset:54112
    v_cvt_pk_bf16_f32 v222, v124, v125
    v_mfma_f32_32x32x16_bf16 v[144:159], v[172:175], a[116:119], v[144:159]
    ds_read_b64_tr_b16 v[164:165], v30 offset:53952
    ds_read_b64_tr_b16 v[166:167], v30 offset:54176
    v_cvt_pk_bf16_f32 v223, v126, v127
    buffer_store_dwordx4 v[220:223], v54, s[32:35], s82 offen offset:3072 sc1
    s_waitcnt lgkmcnt(4)
    v_mfma_f32_32x32x16_bf16 v[128:143], v[176:179], a[120:123], v[128:143]
    s_waitcnt vmcnt(4)
    ds_read_b64_tr_b16 a[248:249], v14 offset:2048
    ds_read_b64_tr_b16 a[250:251], v14 offset:3072
    v_mfma_f32_32x32x16_bf16 v[144:159], v[180:183], a[120:123], v[144:159]
    ds_read_b64_tr_b16 a[252:253], v15 offset:2048
    ds_read_b64_tr_b16 a[254:255], v15 offset:3072
    s_waitcnt lgkmcnt(4)
    v_mfma_f32_32x32x16_bf16 v[128:143], v[160:163], a[124:127], v[128:143]
    v_mfma_f32_32x32x16_bf16 v[144:159], v[164:167], a[124:127], v[144:159]
    s_waitcnt lgkmcnt(0)
    s_barrier
    s_lshl_b32 s68, s52, 4
    s_add_u32 m0, s65, 16384
    s_nop 0
    buffer_load_dwordx4 v2, s[20:23], s68 offen lds
    s_nop 4
    v_max_f32 v128, 0, v128
    v_max_f32 v129, 0, v129
    v_max_f32 v130, 0, v130
    v_max_f32 v131, 0, v131
    v_max_f32 v132, 0, v132
    v_max_f32 v133, 0, v133
    v_max_f32 v134, 0, v134
    v_max_f32 v135, 0, v135
    v_pk_mul_f32 v[128:129], v[128:129], v[128:129]
    v_pk_mul_f32 v[130:131], v[130:131], v[130:131]
    v_pk_mul_f32 v[132:133], v[132:133], v[132:133]
    v_pk_mul_f32 v[134:135], v[134:135], v[134:135]
    buffer_load_dwordx4 v3, s[20:23], s68 offen offset:1024 lds
    v_cvt_pk_bf16_f32 v208, v128, v129
    v_cvt_pk_bf16_f32 v209, v130, v131
    v_cvt_pk_bf16_f32 v210, v132, v133
    v_cvt_pk_bf16_f32 v211, v134, v135
    buffer_store_dwordx4 v[208:211], v54, s[32:35], s83 offen sc1
    v_max_f32 v136, 0, v136
    v_max_f32 v137, 0, v137
    v_max_f32 v138, 0, v138
    v_max_f32 v139, 0, v139
    v_max_f32 v140, 0, v140
    v_max_f32 v141, 0, v141
    v_max_f32 v142, 0, v142
    buffer_load_dwordx4 v4, s[20:23], s68 offen offset:2048 lds
    v_max_f32 v143, 0, v143
    v_pk_mul_f32 v[136:137], v[136:137], v[136:137]
    v_pk_mul_f32 v[138:139], v[138:139], v[138:139]
    v_pk_mul_f32 v[140:141], v[140:141], v[140:141]
    v_pk_mul_f32 v[142:143], v[142:143], v[142:143]
    v_cvt_pk_bf16_f32 v212, v136, v137
    v_cvt_pk_bf16_f32 v213, v138, v139
    v_cvt_pk_bf16_f32 v214, v140, v141
    v_cvt_pk_bf16_f32 v215, v142, v143
    buffer_store_dwordx4 v[212:215], v54, s[32:35], s83 offen offset:1024 sc1
    v_max_f32 v144, 0, v144
    v_max_f32 v145, 0, v145
    buffer_load_dwordx4 v5, s[20:23], s68 offen offset:3072 lds
    v_max_f32 v146, 0, v146
    v_max_f32 v147, 0, v147
    v_max_f32 v148, 0, v148
    v_max_f32 v149, 0, v149
    v_max_f32 v150, 0, v150
    v_max_f32 v151, 0, v151
    v_pk_mul_f32 v[144:145], v[144:145], v[144:145]
    v_pk_mul_f32 v[146:147], v[146:147], v[146:147]
    v_pk_mul_f32 v[148:149], v[148:149], v[148:149]
    v_pk_mul_f32 v[150:151], v[150:151], v[150:151]
    v_cvt_pk_bf16_f32 v216, v144, v145
    v_cvt_pk_bf16_f32 v217, v146, v147
    s_lshl_b32 s68, s53, 4
    s_add_u32 m0, s65, 20480
    s_nop 0
    buffer_load_dwordx4 v2, s[20:23], s68 offen lds
    v_cvt_pk_bf16_f32 v218, v148, v149
    v_cvt_pk_bf16_f32 v219, v150, v151
    buffer_store_dwordx4 v[216:219], v54, s[32:35], s83 offen offset:2048 sc1
    v_pk_mul_f32 v[60:61], v[80:81], v[44:45] op_sel_hi:[1,0]
    v_pk_mul_f32 v[62:63], v[80:81], v[42:43] op_sel:[0,1] op_sel_hi:[1,1]
    v_pk_fma_f32 v[80:81], v[64:65], v[44:45], v[62:63] op_sel_hi:[1,0,1] neg_lo:[0,1,1] neg_hi:[0,1,1]
    v_pk_fma_f32 v[64:65], v[64:65], v[42:43], v[60:61] op_sel:[0,1,0] op_sel_hi:[1,1,1] neg_lo:[0,0,1] neg_hi:[0,0,1]
    v_pk_mul_f32 v[60:61], v[82:83], v[44:45] op_sel_hi:[1,0]
    v_pk_mul_f32 v[62:63], v[82:83], v[42:43] op_sel:[0,1] op_sel_hi:[1,1]
    v_pk_fma_f32 v[82:83], v[66:67], v[44:45], v[62:63] op_sel_hi:[1,0,1] neg_lo:[0,1,1] neg_hi:[0,1,1]
    v_pk_fma_f32 v[66:67], v[66:67], v[42:43], v[60:61] op_sel:[0,1,0] op_sel_hi:[1,1,1] neg_lo:[0,0,1] neg_hi:[0,0,1]
    v_pk_mul_f32 v[60:61], v[84:85], v[44:45] op_sel_hi:[1,0]
    buffer_load_dwordx4 v3, s[20:23], s68 offen offset:1024 lds
    v_pk_mul_f32 v[62:63], v[84:85], v[42:43] op_sel:[0,1] op_sel_hi:[1,1]
    v_pk_fma_f32 v[84:85], v[68:69], v[44:45], v[62:63] op_sel_hi:[1,0,1] neg_lo:[0,1,1] neg_hi:[0,1,1]
    v_pk_fma_f32 v[68:69], v[68:69], v[42:43], v[60:61] op_sel:[0,1,0] op_sel_hi:[1,1,1] neg_lo:[0,0,1] neg_hi:[0,0,1]
    v_pk_mul_f32 v[60:61], v[86:87], v[44:45] op_sel_hi:[1,0]
    v_pk_mul_f32 v[62:63], v[86:87], v[42:43] op_sel:[0,1] op_sel_hi:[1,1]
    v_pk_fma_f32 v[86:87], v[70:71], v[44:45], v[62:63] op_sel_hi:[1,0,1] neg_lo:[0,1,1] neg_hi:[0,1,1]
    v_pk_fma_f32 v[70:71], v[70:71], v[42:43], v[60:61] op_sel:[0,1,0] op_sel_hi:[1,1,1] neg_lo:[0,0,1] neg_hi:[0,0,1]
    v_pk_mul_f32 v[60:61], v[88:89], v[44:45] op_sel_hi:[1,0]
    v_pk_mul_f32 v[62:63], v[88:89], v[42:43] op_sel:[0,1] op_sel_hi:[1,1]
    v_pk_fma_f32 v[88:89], v[72:73], v[44:45], v[62:63] op_sel_hi:[1,0,1] neg_lo:[0,1,1] neg_hi:[0,1,1]
    v_pk_fma_f32 v[72:73], v[72:73], v[42:43], v[60:61] op_sel:[0,1,0] op_sel_hi:[1,1,1] neg_lo:[0,0,1] neg_hi:[0,0,1]
    v_pk_mul_f32 v[60:61], v[90:91], v[44:45] op_sel_hi:[1,0]
    buffer_load_dwordx4 v4, s[20:23], s68 offen offset:2048 lds
    v_pk_mul_f32 v[62:63], v[90:91], v[42:43] op_sel:[0,1] op_sel_hi:[1,1]
    v_pk_fma_f32 v[90:91], v[74:75], v[44:45], v[62:63] op_sel_hi:[1,0,1] neg_lo:[0,1,1] neg_hi:[0,1,1]
    v_pk_fma_f32 v[74:75], v[74:75], v[42:43], v[60:61] op_sel:[0,1,0] op_sel_hi:[1,1,1] neg_lo:[0,0,1] neg_hi:[0,0,1]
    v_pk_mul_f32 v[60:61], v[92:93], v[44:45] op_sel_hi:[1,0]
    v_pk_mul_f32 v[62:63], v[92:93], v[42:43] op_sel:[0,1] op_sel_hi:[1,1]
    v_pk_fma_f32 v[92:93], v[76:77], v[44:45], v[62:63] op_sel_hi:[1,0,1] neg_lo:[0,1,1] neg_hi:[0,1,1]
    v_pk_fma_f32 v[76:77], v[76:77], v[42:43], v[60:61] op_sel:[0,1,0] op_sel_hi:[1,1,1] neg_lo:[0,0,1] neg_hi:[0,0,1]
    v_pk_mul_f32 v[60:61], v[94:95], v[44:45] op_sel_hi:[1,0]
    v_pk_mul_f32 v[62:63], v[94:95], v[42:43] op_sel:[0,1] op_sel_hi:[1,1]
    v_pk_fma_f32 v[94:95], v[78:79], v[44:45], v[62:63] op_sel_hi:[1,0,1] neg_lo:[0,1,1] neg_hi:[0,1,1]
    v_pk_fma_f32 v[78:79], v[78:79], v[42:43], v[60:61] op_sel:[0,1,0] op_sel_hi:[1,1,1] neg_lo:[0,0,1] neg_hi:[0,0,1]
    s_waitcnt vmcnt(11)
    s_mov_b64 exec, s[74:75]
    v_cmp_ne_u32 s[78:79], v49, v225
    v_cmp_ne_u32 s[80:81], v49, v227
    s_nop 3
    s_or_b64 s[78:79], s[78:79], s[80:81]
    s_mov_b64 exec, s[76:77]
    v_cmp_ne_u32 vcc, v49, v229
    v_cmp_ne_u32 s[80:81], v49, v231
    s_nop 3
    s_or_b64 s[78:79], s[78:79], vcc
    s_mov_b64 exec, -1
    s_or_b64 s[78:79], s[78:79], s[80:81]
    s_cbranch_scc1 L_e_slow
L_eok:
    buffer_load_dwordx4 v5, s[20:23], s68 offen offset:3072 lds
    v_mul_f32 v60, v39, v224
    v_mul_f32 v61, v39, v226
    v_fma_f32 v60, -v40, v226, v60
    v_fmac_f32 v61, v40, v224
    v_fmac_f32 v60, v41, v228
    v_fmac_f32 v61, v41, v230
    v_fma_f32 v60, -v42, v230, v60
    v_fmac_f32 v61, v42, v228
    v_lshlrev_b32 v59, 3, v0
    v_add_u32 v59, 151552, v59
    ds_write_b64 v59, v[60:61]
    s_waitcnt vmcnt(3)
    s_waitcnt lgkmcnt(0)
    s_barrier
    s_cmp_lg_u32 s60, 0
    s_cbranch_scc1 L_noflag_f
    s_lshl_b32 s101, s58, 5
    s_add_u32 s101, s101, s59
    s_lshl_b32 s101, s101, 2
    s_add_u32 s101, s101, 11681792
    v_mov_b32 v62, 0
    v_mov_b32 v63, s63
    s_mov_b64 exec, 1
    buffer_store_dword v63, v62, s[32:35], s101 offen sc1
    s_mov_b64 exec, -1
L_noflag_f:
    s_lshl_b32 s68, s54, 4
    s_add_u32 m0, s65, 24576
    s_nop 0
    buffer_load_dwordx4 v2, s[20:23], s68 offen lds
    v_lshlrev_b32_e64 v59, 3, v50
    v_add_u32 v59, 151552, v59
    ds_read_b64 v[234:235], v59 offset:0
    ds_read_b64 v[236:237], v59 offset:256
    ds_read_b64 v[238:239], v59 offset:512
    ds_read_b64 v[240:241], v59 offset:768
    ds_read_b64 v[242:243], v59 offset:1024
    ds_read_b64 v[244:245], v59 offset:1280
    ds_read_b64 v[246:247], v59 offset:1536
    ds_read_b64 v[248:249], v59 offset:1792
    s_waitcnt lgkmcnt(0)
    v_add_f32 v234, v234, v236
    buffer_load_dwordx4 v3, s[20:23], s68 offen offset:1024 lds
    v_add_f32 v235, v235, v237
    v_add_f32 v238, v238, v240
    v_add_f32 v239, v239, v241
    v_add_f32 v242, v242, v244
    v_add_f32 v243, v243, v245
    v_add_f32 v246, v246, v248
    v_add_f32 v247, v247, v249
    v_add_f32 v234, v234, v238
    v_add_f32 v235, v235, v239
    v_add_f32 v242, v242, v246
    v_add_f32 v243, v243, v247
    v_add_f32 v234, v234, v242
    buffer_load_dwordx4 v4, s[20:23], s68 offen offset:2048 lds
    v_add_f32_e64 v235, v235, v243
    v_fma_f32 v60, v37, v234, v48
    v_fma_f32 v61, v37, v235, v45
    v_fma_f32 v60, -v38, v235, v60
    v_fmac_f32 v61, v38, v234
    v_mul_f32 v62, v43, v60
    v_mul_f32_e64 v63, v43, v61
    v_fma_f32 v62, -v44, v61, v62
    v_fmac_f32 v63, v44, v60
    v_sub_f32 v63, 0, v63
    v_fmac_f32 v64, v33, v62
    v_fmac_f32 v80, v33, v63
    buffer_load_dwordx4 v5, s[20:23], s68 offen offset:3072 lds
    v_fmac_f32 v64, v34, v63
    v_fma_f32 v80, -v34, v62, v80
    v_fmac_f32 v65, v33, v64
    v_fmac_f32 v81, v33, v80
    v_fmac_f32 v65, v34, v80
    v_fma_f32 v81, -v34, v64, v81
    v_fmac_f32 v66, v33, v65
    v_fmac_f32 v82, v33, v81
    v_fmac_f32 v66, v34, v81
    v_fma_f32 v82, -v34, v65, v82
    v_fmac_f32 v67, v33, v66
    v_fmac_f32 v83, v33, v82
    s_lshl_b32 s68, s55, 4
    s_add_u32 m0, s65, 28672
    s_nop 0
    buffer_load_dwordx4 v2, s[20:23], s68 offen lds
    v_fmac_f32 v67, v34, v82
    v_fma_f32 v83, -v34, v66, v83
    v_fmac_f32 v68, v33, v67
    v_fmac_f32 v84, v33, v83
    v_fmac_f32 v68, v34, v83
    v_fma_f32 v84, -v34, v67, v84
    v_fmac_f32 v69, v33, v68
    v_fmac_f32 v85, v33, v84
    v_fmac_f32 v69, v34, v84
    v_fma_f32 v85, -v34, v68, v85
    v_fmac_f32 v70, v33, v69
    v_fmac_f32 v86, v33, v85
    buffer_load_dwordx4 v3, s[20:23], s68 offen offset:1024 lds
    v_fmac_f32_e64 v70, v34, v85
    v_fma_f32 v86, -v34, v69, v86
    v_fmac_f32 v71, v33, v70
    v_fmac_f32 v87, v33, v86
    v_fmac_f32 v71, v34, v86
    v_fma_f32 v87, -v34, v70, v87
    v_fmac_f32 v72, v33, v71
    v_fmac_f32 v88, v33, v87
    v_fmac_f32 v72, v34, v87
    v_fma_f32 v88, -v34, v71, v88
    v_fmac_f32 v73, v33, v72
    v_fmac_f32 v89, v33, v88
    buffer_load_dwordx4 v4, s[20:23], s68 offen offset:2048 lds
    v_fmac_f32 v73, v34, v88
    v_fma_f32 v89, -v34, v72, v89
    v_fmac_f32 v74, v33, v73
    v_fmac_f32 v90, v33, v89
    v_fmac_f32 v74, v34, v89
    v_fma_f32 v90, -v34, v73, v90
    v_fmac_f32 v75, v33, v74
    v_fmac_f32 v91, v33, v90
    v_fmac_f32 v75, v34, v90
    v_fma_f32 v91, -v34, v74, v91
    v_fmac_f32 v76, v33, v75
    v_fmac_f32_e64 v92, v33, v91
    buffer_load_dwordx4 v5, s[20:23], s68 offen offset:3072 lds
    v_fmac_f32 v76, v34, v91
    v_fma_f32 v92, -v34, v75, v92
    v_fmac_f32 v77, v33, v76
    v_fmac_f32 v93, v33, v92
    v_fmac_f32 v77, v34, v92
    v_fma_f32 v93, -v34, v76, v93
    v_fmac_f32 v78, v33, v77
    v_fmac_f32 v94, v33, v93
    v_fmac_f32 v78, v34, v93
    v_fma_f32 v94, -v34, v77, v94
    v_fmac_f32 v79, v33, v78
    v_fmac_f32 v95, v33, v94
    s_lshl_b32 s68, s56, 4
    s_add_u32 m0, s65, 32768
    s_nop 0
    buffer_load_dwordx4 v2, s[20:23], s68 offen lds
    v_fmac_f32 v79, v34, v94
    v_fma_f32 v95, -v34, v78, v95
    v_cvt_pk_bf16_f32 v208, v64, v65
    v_cvt_pk_bf16_f32 v209, v66, v67
    v_cvt_pk_bf16_f32 v210, v68, v69
    v_cvt_pk_bf16_f32 v211, v70, v71
    v_cvt_pk_bf16_f32 v212, v72, v73
    v_cvt_pk_bf16_f32 v213, v74, v75
    v_cvt_pk_bf16_f32 v214, v76, v77
    v_cvt_pk_bf16_f32 v215, v78, v79
    v_cvt_pk_bf16_f32 v216, v80, v81
    v_cvt_pk_bf16_f32 v217, v82, v83
    buffer_load_dwordx4 v3, s[20:23], s68 offen offset:1024 lds
    v_cvt_pk_bf16_f32 v218, v84, v85
    v_cvt_pk_bf16_f32 v219, v86, v87
    v_cvt_pk_bf16_f32 v220, v88, v89
    v_cvt_pk_bf16_f32 v221, v90, v91
    v_cvt_pk_bf16_f32 v222, v92, v93
    v_cvt_pk_bf16_f32 v223, v94, v95
    ds_write_b128 v58, v[208:211]
    ds_write_b128 v56, v[212:215]
    s_waitcnt lgkmcnt(0)
    ds_read_b64_tr_b16 v[234:235], v53 offset:0
    ds_read_b64_tr_b16 v[236:237], v57 offset:256
    ds_read_b64_tr_b16 v[238:239], v53 offset:1024
    buffer_load_dwordx4 v4, s[20:23], s68 offen offset:2048 lds
    ds_read_b64_tr_b16 v[240:241], v57 offset:1280
    s_waitcnt lgkmcnt(2)
    buffer_store_dwordx4 v[234:237], v54, s[32:35], s84 offen sc1
    s_waitcnt lgkmcnt(0)
    buffer_store_dwordx4 v[238:241], v54, s[32:35], s84 offen offset:1024 sc1
    ds_write_b128 v58, v[216:219]
    ds_write_b128 v56, v[220:223]
    s_waitcnt lgkmcnt(0)
    ds_read_b64_tr_b16 v[242:243], v53 offset:0
    ds_read_b64_tr_b16 v[244:245], v57 offset:256
    ds_read_b64_tr_b16 v[246:247], v53 offset:1024
    ds_read_b64_tr_b16 v[248:249], v57 offset:1280
    buffer_load_dwordx4 v5, s[20:23], s68 offen offset:3072 lds
    s_waitcnt lgkmcnt(2)
    buffer_store_dwordx4 v[242:245], v54, s[32:35], s84 offen offset:2048 sc1
    s_waitcnt lgkmcnt(0)
    buffer_store_dwordx4 v[246:249], v54, s[32:35], s84 offen offset:3072 sc1
    s_lshl_b32 s68, s57, 4
    s_add_u32 m0, s65, s99
    s_nop 0
    buffer_load_dwordx4 v2, s[20:23], s68 offen lds
    buffer_load_dwordx4 v3, s[20:23], s68 offen offset:1024 lds
    buffer_load_dwordx4 v4, s[20:23], s68 offen offset:2048 lds
    buffer_load_dwordx4 v5, s[20:23], s68 offen offset:3072 lds
    s_lshl_b32 s68, s96, 2
    s_add_u32 s69, s96, s65
    s_add_u32 m0, s69, 0
    s_nop 0
    buffer_load_dwordx4 v6, s[24:27], s68 offen lds
    buffer_load_dwordx4 v7, s[24:27], s68 offen offset:1024 lds
    buffer_load_dwordx4 v8, s[24:27], s68 offen offset:2048 lds
    buffer_load_dwordx4 v9, s[24:27], s68 offen offset:3072 lds
    s_waitcnt vmcnt(8)
    s_barrier
    s_cmp_lg_u32 s60, 0
    s_cbranch_scc1 L_noflag
    s_lshl_b32 s101, s58, 5
    s_add_u32 s101, s101, s59
    s_lshl_b32 s101, s101, 2
    s_add_u32 s101, s101, 11683840
    v_mov_b32 v62, 0
    v_mov_b32 v63, s63
    s_mov_b64 exec, 1
    buffer_store_dword v63, v62, s[32:35], s101 offen sc1
    s_mov_b64 exec, -1
L_noflag:
    s_lshl_b32 s68, s97, 2
    s_add_u32 s69, s97, s65
    s_add_u32 m0, s69, 0
    s_nop 0
    buffer_load_dwordx4 v6, s[24:27], s68 offen lds
    buffer_load_dwordx4 v7, s[24:27], s68 offen offset:1024 lds
    buffer_load_dwordx4 v8, s[24:27], s68 offen offset:2048 lds
    buffer_load_dwordx4 v9, s[24:27], s68 offen offset:3072 lds
    s_lshl_b32 s68, s98, 2
    s_add_u32 s69, s98, s65
    s_add_u32 m0, s69, 0
    s_nop 0
    buffer_load_dwordx4 v6, s[24:27], s68 offen lds
    buffer_load_dwordx4 v7, s[24:27], s68 offen offset:1024 lds
    buffer_load_dwordx4 v8, s[24:27], s68 offen offset:2048 lds
    buffer_load_dwordx4 v9, s[24:27], s68 offen offset:3072 lds
    s_lshl_b32 s101, s61, 1
    s_mul_i32 s101, s101, 180224
    s_mul_i32 s85, s60, 28672
    s_add_u32 s85, s85, s101
    v_add_u32_e64 v36, s85, v54
    v_add_u32 v37, 180224, v36
    s_lshl_b32 s85, s60, 14
    s_add_u32 s85, s85, s101
    s_add_u32 s85, s85, 114688
    v_add_u32 v38, s85, v54
    v_add_u32 v39, 180224, v38
    s_lshl_b32 s101, s61, 6
    s_lshl_b32 s85, s60, 4
    s_add_u32 s101, s101, s85
    v_lshrrev_b32 v26, 4, v1
    v_add_u32 v26, s101, v26
    s_lshl_b32 s85, s62, 7
    v_and_b32 v27, 15, v1
    v_lshlrev_b32 v27, 3, v27
    v_add_u32 v27, s85, v27
    v_lshl_add_u32 v26, v26, 10, v27
    s_lshr_b32 s101, s61, 1
    s_lshl_b32 s101, s101, 7
    s_add_u32 s87, s101, 11681792
    v_and_b32 v30, 15, v1
    v_lshlrev_b32 v30, 2, v30
    v_mov_b32 v40, v250
    v_mov_b32 v41, v251
    v_mov_b32 v42, v252
    v_mov_b32 v43, v253
    v_and_b32 v59, 15, v50
    v_xor_b32 v59, v59, v51
    v_lshlrev_b32 v59, 4, v59
    v_lshl_add_u32 v59, v50, 8, v59
    v_add_u32 v59, s65, v59
    s_lshr_b32 s72, s92, 6
    v_xor_b32 v18, s72, v59
    v_xor_b32 v19, 32, v18
    s_lshr_b32 s72, s93, 6
    v_xor_b32 v20, s72, v59
    v_xor_b32 v21, 32, v20
    s_lshr_b32 s72, s94, 6
    v_xor_b32 v22, s72, v59
    v_xor_b32 v23, 32, v22
    s_lshr_b32 s72, s95, 6
    v_xor_b32 v24, s72, v59
    v_xor_b32 v25, 32, v24
    ds_read_b64_tr_b16 a[0:1], v16 offset:16384
    ds_read_b64_tr_b16 a[2:3], v16 offset:17408
    ds_read_b64_tr_b16 a[4:5], v17 offset:16384
    ds_read_b64_tr_b16 a[6:7], v17 offset:17408
    ds_read_b64_tr_b16 a[8:9], v16 offset:18432
    ds_read_b64_tr_b16 a[10:11], v16 offset:19456
    ds_read_b64_tr_b16 a[12:13], v17 offset:18432
    ds_read_b64_tr_b16 a[14:15], v17 offset:19456
    ds_read_b64_tr_b16 a[16:17], v16 offset:20480
    ds_read_b64_tr_b16 a[18:19], v16 offset:21504
    ds_read_b64_tr_b16 a[20:21], v17 offset:20480
    ds_read_b64_tr_b16 a[22:23], v17 offset:21504
    ds_read_b64_tr_b16 a[24:25], v16 offset:22528
    ds_read_b64_tr_b16 a[26:27], v16 offset:23552
    ds_read_b64_tr_b16 a[28:29], v17 offset:22528
    ds_read_b64_tr_b16 a[30:31], v17 offset:23552
    ds_read_b64_tr_b16 a[32:33], v16 offset:24576
    ds_read_b64_tr_b16 a[34:35], v16 offset:25600
    ds_read_b64_tr_b16 a[36:37], v17 offset:24576
    ds_read_b64_tr_b16 a[38:39], v17 offset:25600
    ds_read_b64_tr_b16 a[40:41], v16 offset:26624
    ds_read_b64_tr_b16 a[42:43], v16 offset:27648
    ds_read_b64_tr_b16 a[44:45], v17 offset:26624
    ds_read_b64_tr_b16 a[46:47], v17 offset:27648
    ds_read_b64_tr_b16 a[48:49], v16 offset:28672
    ds_read_b64_tr_b16 a[50:51], v16 offset:29696
    ds_read_b64_tr_b16 a[52:53], v17 offset:28672
    ds_read_b64_tr_b16 a[54:55], v17 offset:29696
    ds_read_b64_tr_b16 a[56:57], v16 offset:30720
    ds_read_b64_tr_b16 a[58:59], v16 offset:31744
    ds_read_b64_tr_b16 a[60:61], v17 offset:30720
    ds_read_b64_tr_b16 a[62:63], v17 offset:31744
    ds_read_b64_tr_b16 a[64:65], v16 offset:32768
    ds_read_b64_tr_b16 a[66:67], v16 offset:33792
    ds_read_b64_tr_b16 a[68:69], v17 offset:32768
    ds_read_b64_tr_b16 a[70:71], v17 offset:33792
    ds_read_b64_tr_b16 a[72:73], v16 offset:34816
    ds_read_b64_tr_b16 a[74:75], v16 offset:35840
    ds_read_b64_tr_b16 a[76:77], v17 offset:34816
    ds_read_b64_tr_b16 a[78:79], v17 offset:35840
    s_waitcnt vmcnt(14)
    ds_read_b64_tr_b16 a[80:81], v12 offset:0
    ds_read_b64_tr_b16 a[82:83], v12 offset:1024
    ds_read_b64_tr_b16 a[84:85], v13 offset:0
    ds_read_b64_tr_b16 a[86:87], v13 offset:1024
    s_waitcnt vmcnt(12)
    ds_read_b64_tr_b16 a[88:89], v12 offset:2048
    ds_read_b64_tr_b16 a[90:91], v12 offset:3072
    ds_read_b64_tr_b16 a[92:93], v13 offset:2048
    ds_read_b64_tr_b16 a[94:95], v13 offset:3072
    s_waitcnt lgkmcnt(0)
    s_lshl_b32 s68, s99, 2
    s_add_u32 s69, s99, s65
    s_add_u32 m0, s69, 0
    s_nop 0
    buffer_load_dwordx4 v6, s[24:27], s68 offen lds
    buffer_load_dwordx4 v7, s[24:27], s68 offen offset:1024 lds
    buffer_load_dwordx4 v8, s[24:27], s68 offen offset:2048 lds
    buffer_load_dwordx4 v9, s[24:27], s68 offen offset:3072 lds
    s_lshl_b32 s68, s96, 2
    s_add_u32 s69, s96, s65
    s_add_u32 m0, s69, 16384
    s_nop 0
    buffer_load_dwordx4 v6, s[28:31], s68 offen lds
    buffer_load_dwordx4 v7, s[28:31], s68 offen offset:1024 lds
    buffer_load_dwordx4 v8, s[28:31], s68 offen offset:2048 lds
    buffer_load_dwordx4 v9, s[28:31], s68 offen offset:3072 lds
    s_lshl_b32 s68, s97, 2
    s_add_u32 s69, s97, s65
    s_add_u32 m0, s69, 16384
    s_nop 0
    buffer_load_dwordx4 v6, s[28:31], s68 offen lds
    buffer_load_dwordx4 v7, s[28:31], s68 offen offset:1024 lds
    buffer_load_dwordx4 v8, s[28:31], s68 offen offset:2048 lds
    buffer_load_dwordx4 v9, s[28:31], s68 offen offset:3072 lds
    buffer_load_dword v31, v30, s[32:35], s87 offen sc1
    s_lshl_b32 s68, s98, 2
    s_add_u32 s69, s98, s65
    s_add_u32 m0, s69, 16384
    s_nop 0
    buffer_load_dwordx4 v6, s[28:31], s68 offen lds
    buffer_load_dwordx4 v7, s[28:31], s68 offen offset:1024 lds
    buffer_load_dwordx4 v8, s[28:31], s68 offen offset:2048 lds
    buffer_load_dwordx4 v9, s[28:31], s68 offen offset:3072 lds
    s_lshl_b32 s68, s99, 2
    s_add_u32 s69, s99, s65
    s_add_u32 m0, s69, 16384
    s_nop 0
    buffer_load_dwordx4 v6, s[28:31], s68 offen lds
    buffer_load_dwordx4 v7, s[28:31], s68 offen offset:1024 lds
    buffer_load_dwordx4 v8, s[28:31], s68 offen offset:2048 lds
    buffer_load_dwordx4 v9, s[28:31], s68 offen offset:3072 lds
    s_waitcnt vmcnt(8)
    v_cmp_ne_u32 vcc, s63, v31
    s_nop 4
    s_cbranch_vccnz L_f_slow
L_fok:
    buffer_load_dwordx4 a[96:99], v36, s[32:35], s44 offen sc1
    buffer_load_dwordx4 a[100:103], v37, s[32:35], s44 offen sc1
    buffer_load_dwordx4 a[104:107], v36, s[32:35], s44 offen offset:1024 sc1
    buffer_load_dwordx4 a[108:111], v37, s[32:35], s44 offen offset:1024 sc1
    buffer_load_dwordx4 a[112:115], v36, s[32:35], s45 offen sc1
    buffer_load_dwordx4 a[116:119], v37, s[32:35], s45 offen sc1
    buffer_load_dwordx4 a[120:123], v36, s[32:35], s45 offen offset:1024 sc1
    buffer_load_dwordx4 a[124:127], v37, s[32:35], s45 offen offset:1024 sc1
    buffer_load_dwordx4 v[208:211], v36, s[32:35], s46 offen sc1
    buffer_load_dwordx4 v[212:215], v37, s[32:35], s46 offen sc1
    buffer_load_dwordx4 v[216:219], v36, s[32:35], s46 offen offset:1024 sc1
    buffer_load_dwordx4 v[220:223], v37, s[32:35], s46 offen offset:1024 sc1
    buffer_load_dwordx4 v[224:227], v36, s[32:35], s47 offen sc1
    buffer_load_dwordx4 v[228:231], v37, s[32:35], s47 offen sc1
    buffer_load_dwordx4 v[232:235], v36, s[32:35], s47 offen offset:1024 sc1
    buffer_load_dwordx4 v[236:239], v37, s[32:35], s47 offen offset:1024 sc1
    s_lshl_b32 s72, s61, 9
    s_add_u32 s72, s72, 11534336
    v_lshlrev_b32 v32, 3, v1
    buffer_load_dwordx2 v[34:35], v32, s[32:35], s72 offen sc1
    s_waitcnt vmcnt(15)
    v_mfma_f32_32x32x16_bf16 v[64:79], a[96:99], a[128:131], 0
    buffer_load_dwordx4 v[240:243], v36, s[32:35], s48 offen sc1
    v_mfma_f32_32x32x16_bf16 v[80:95], a[96:99], a[132:135], 0
    v_mfma_f32_32x32x16_bf16 v[96:111], a[100:103], a[128:131], 0
    buffer_load_dwordx4 v[244:247], v37, s[32:35], s48 offen sc1
    v_mfma_f32_32x32x16_bf16 v[112:127], a[100:103], a[132:135], 0
    s_waitcnt vmcnt(15)
    v_mfma_f32_32x32x16_bf16 v[64:79], a[104:107], a[136:139], v[64:79]
    buffer_load_dwordx4 v[248:251], v36, s[32:35], s48 offen offset:1024 sc1
    v_mfma_f32_32x32x16_bf16 v[80:95], a[104:107], a[140:143], v[80:95]
    v_mfma_f32_32x32x16_bf16 v[96:111], a[108:111], a[136:139], v[96:111]
    buffer_load_dwordx4 v[252:255], v37, s[32:35], s48 offen offset:1024 sc1
    v_mfma_f32_32x32x16_bf16 v[112:127], a[108:111], a[140:143], v[112:127]
    s_waitcnt vmcnt(15)
    v_mfma_f32_32x32x16_bf16 v[64:79], a[112:115], a[144:147], v[64:79]
    buffer_load_dwordx4 a[128:131], v36, s[32:35], s49 offen sc1
    v_mfma_f32_32x32x16_bf16 v[80:95], a[112:115], a[148:151], v[80:95]
    v_mfma_f32_32x32x16_bf16 v[96:111], a[116:119], a[144:147], v[96:111]
    buffer_load_dwordx4 a[132:135], v37, s[32:35], s49 offen sc1
    v_mfma_f32_32x32x16_bf16 v[112:127], a[116:119], a[148:151], v[112:127]
    s_waitcnt vmcnt(15)
    v_mfma_f32_32x32x16_bf16 v[64:79], a[120:123], a[152:155], v[64:79]
    buffer_load_dwordx4 a[136:139], v36, s[32:35], s49 offen offset:1024 sc1
    v_mfma_f32_32x32x16_bf16 v[80:95], a[120:123], a[156:159], v[80:95]
    v_mfma_f32_32x32x16_bf16 v[96:111], a[124:127], a[152:155], v[96:111]
    buffer_load_dwordx4 a[140:143], v37, s[32:35], s49 offen offset:1024 sc1
    v_mfma_f32_32x32x16_bf16 v[112:127], a[124:127], a[156:159], v[112:127]
    s_waitcnt vmcnt(15)
    v_mfma_f32_32x32x16_bf16 v[64:79], v[208:211], a[160:163], v[64:79]
    buffer_load_dwordx4 a[144:147], v36, s[32:35], s50 offen sc1
    v_mfma_f32_32x32x16_bf16 v[80:95], v[208:211], a[164:167], v[80:95]
    v_mfma_f32_32x32x16_bf16 v[96:111], v[212:215], a[160:163], v[96:111]
    buffer_load_dwordx4 a[148:151], v37, s[32:35], s50 offen sc1
    v_mfma_f32_32x32x16_bf16 v[112:127], v[212:215], a[164:167], v[112:127]
    s_waitcnt vmcnt(15)
    v_mfma_f32_32x32x16_bf16 v[64:79], v[216:219], a[168:171], v[64:79]
    buffer_load_dwordx4 a[152:155], v36, s[32:35], s50 offen offset:1024 sc1
    v_mfma_f32_32x32x16_bf16 v[80:95], v[216:219], a[172:175], v[80:95]
    v_mfma_f32_32x32x16_bf16 v[96:111], v[220:223], a[168:171], v[96:111]
    buffer_load_dwordx4 a[156:159], v37, s[32:35], s50 offen offset:1024 sc1
    v_mfma_f32_32x32x16_bf16 v[112:127], v[220:223], a[172:175], v[112:127]
    s_waitcnt vmcnt(15)
    v_mfma_f32_32x32x16_bf16 v[64:79], v[224:227], a[176:179], v[64:79]
    buffer_load_dwordx4 a[160:163], v36, s[32:35], s51 offen sc1
    s_waitcnt vmcnt(13)
    v_lshlrev_b32 v32, 2, v1
    v_add_u32 v32, 153600, v32
    ds_write_b32 v32, v34
    ds_write_b32 v32, v35 offset:256
    v_mfma_f32_32x32x16_bf16 v[80:95], v[224:227], a[180:183], v[80:95]
    v_mfma_f32_32x32x16_bf16 v[96:111], v[228:231], a[176:179], v[96:111]
    buffer_load_dwordx4 a[164:167], v37, s[32:35], s51 offen sc1
    v_mfma_f32_32x32x16_bf16 v[112:127], v[228:231], a[180:183], v[112:127]
    v_mfma_f32_32x32x16_bf16 v[64:79], v[232:235], a[184:187], v[64:79]
    buffer_load_dwordx4 a[168:171], v36, s[32:35], s51 offen offset:1024 sc1
    v_mfma_f32_32x32x16_bf16 v[80:95], v[232:235], a[188:191], v[80:95]
    v_mfma_f32_32x32x16_bf16 v[96:111], v[236:239], a[184:187], v[96:111]
    buffer_load_dwordx4 a[172:175], v37, s[32:35], s51 offen offset:1024 sc1
    v_mfma_f32_32x32x16_bf16 v[112:127], v[236:239], a[188:191], v[112:127]
    s_waitcnt vmcnt(14)
    v_mfma_f32_32x32x16_bf16 v[64:79], v[240:243], a[192:195], v[64:79]
    buffer_load_dwordx4 a[176:179], v36, s[32:35], s52 offen sc1
    v_mfma_f32_32x32x16_bf16 v[80:95], v[240:243], a[196:199], v[80:95]
    v_mfma_f32_32x32x16_bf16 v[96:111], v[244:247], a[192:195], v[96:111]
    buffer_load_dwordx4 a[180:183], v37, s[32:35], s52 offen sc1
    v_mfma_f32_32x32x16_bf16 v[112:127], v[244:247], a[196:199], v[112:127]
    s_waitcnt vmcnt(14)
    v_mfma_f32_32x32x16_bf16 v[64:79], v[248:251], a[200:203], v[64:79]
    buffer_load_dwordx4 a[184:187], v36, s[32:35], s52 offen offset:1024 sc1
    v_mfma_f32_32x32x16_bf16 v[80:95], v[248:251], a[204:207], v[80:95]
    v_mfma_f32_32x32x16_bf16 v[96:111], v[252:255], a[200:203], v[96:111]
    buffer_load_dwordx4 a[188:191], v37, s[32:35], s52 offen offset:1024 sc1
    v_mfma_f32_32x32x16_bf16 v[112:127], v[252:255], a[204:207], v[112:127]
    s_waitcnt vmcnt(14)
    v_mfma_f32_32x32x16_bf16 v[64:79], a[128:131], a[208:211], v[64:79]
    buffer_load_dwordx4 a[192:195], v36, s[32:35], s53 offen sc1
    v_mfma_f32_32x32x16_bf16 v[80:95], a[128:131], a[212:215], v[80:95]
    v_mfma_f32_32x32x16_bf16 v[96:111], a[132:135], a[208:211], v[96:111]
    buffer_load_dwordx4 a[196:199], v37, s[32:35], s53 offen sc1
    v_mfma_f32_32x32x16_bf16 v[112:127], a[132:135], a[212:215], v[112:127]
    s_waitcnt vmcnt(14)
    v_mfma_f32_32x32x16_bf16 v[64:79], a[136:139], a[216:219], v[64:79]
    buffer_load_dwordx4 a[200:203], v36, s[32:35], s53 offen offset:1024 sc1
    v_mfma_f32_32x32x16_bf16 v[80:95], a[136:139], a[220:223], v[80:95]
    v_mfma_f32_32x32x16_bf16 v[96:111], a[140:143], a[216:219], v[96:111]
    buffer_load_dwordx4 a[204:207], v37, s[32:35], s53 offen offset:1024 sc1
    v_mfma_f32_32x32x16_bf16 v[112:127], a[140:143], a[220:223], v[112:127]
    s_waitcnt vmcnt(14)
    v_mfma_f32_32x32x16_bf16 v[64:79], a[144:147], a[224:227], v[64:79]
    buffer_load_dwordx4 a[208:211], v36, s[32:35], s54 offen sc1
    v_mfma_f32_32x32x16_bf16 v[80:95], a[144:147], a[228:231], v[80:95]
    v_mfma_f32_32x32x16_bf16 v[96:111], a[148:151], a[224:227], v[96:111]
    buffer_load_dwordx4 a[212:215], v37, s[32:35], s54 offen sc1
    v_mfma_f32_32x32x16_bf16 v[112:127], a[148:151], a[228:231], v[112:127]
    s_waitcnt vmcnt(14)
    v_mfma_f32_32x32x16_bf16 v[64:79], a[152:155], a[232:235], v[64:79]
    buffer_load_dwordx4 a[216:219], v36, s[32:35], s54 offen offset:1024 sc1
    v_mfma_f32_32x32x16_bf16 v[80:95], a[152:155], a[236:239], v[80:95]
    v_mfma_f32_32x32x16_bf16 v[96:111], a[156:159], a[232:235], v[96:111]
    buffer_load_dwordx4 a[220:223], v37, s[32:35], s54 offen offset:1024 sc1
    v_mfma_f32_32x32x16_bf16 v[112:127], a[156:159], a[236:239], v[112:127]
    s_waitcnt vmcnt(14)
    v_mfma_f32_32x32x16_bf16 v[64:79], a[160:163], a[240:243], v[64:79]
    buffer_load_dwordx4 a[224:227], v36, s[32:35], s55 offen sc1
    v_mfma_f32_32x32x16_bf16 v[80:95], a[160:163], a[244:247], v[80:95]
    v_mfma_f32_32x32x16_bf16 v[96:111], a[164:167], a[240:243], v[96:111]
    buffer_load_dwordx4 a[228:231], v37, s[32:35], s55 offen sc1
    v_mfma_f32_32x32x16_bf16 v[112:127], a[164:167], a[244:247], v[112:127]
    s_waitcnt vmcnt(14)
    v_mfma_f32_32x32x16_bf16 v[64:79], a[168:171], a[248:251], v[64:79]
    buffer_load_dwordx4 a[232:235], v36, s[32:35], s55 offen offset:1024 sc1
    v_mfma_f32_32x32x16_bf16 v[80:95], a[168:171], a[252:255], v[80:95]
    v_mfma_f32_32x32x16_bf16 v[96:111], a[172:175], a[248:251], v[96:111]
    buffer_load_dwordx4 a[236:239], v37, s[32:35], s55 offen offset:1024 sc1
    v_mfma_f32_32x32x16_bf16 v[112:127], a[172:175], a[252:255], v[112:127]
    s_waitcnt vmcnt(14)
    v_mfma_f32_32x32x16_bf16 v[64:79], a[176:179], a[0:3], v[64:79]
    buffer_load_dwordx4 a[240:243], v36, s[32:35], s56 offen sc1
    v_mfma_f32_32x32x16_bf16 v[80:95], a[176:179], a[4:7], v[80:95]
    v_mfma_f32_32x32x16_bf16 v[96:111], a[180:183], a[0:3], v[96:111]
    buffer_load_dwordx4 a[244:247], v37, s[32:35], s56 offen sc1
    v_mfma_f32_32x32x16_bf16 v[112:127], a[180:183], a[4:7], v[112:127]
    s_waitcnt vmcnt(14)
    v_mfma_f32_32x32x16_bf16 v[64:79], a[184:187], a[8:11], v[64:79]
    buffer_load_dwordx4 a[248:251], v36, s[32:35], s56 offen offset:1024 sc1
    v_mfma_f32_32x32x16_bf16 v[80:95], a[184:187], a[12:15], v[80:95]
    v_mfma_f32_32x32x16_bf16 v[96:111], a[188:191], a[8:11], v[96:111]
    buffer_load_dwordx4 a[252:255], v37, s[32:35], s56 offen offset:1024 sc1
    v_mfma_f32_32x32x16_bf16 v[112:127], a[188:191], a[12:15], v[112:127]
    s_waitcnt vmcnt(14)
    v_mfma_f32_32x32x16_bf16 v[64:79], a[192:195], a[16:19], v[64:79]
    buffer_load_dword v31, v30, s[32:35], s87 offen offset:2048 sc1
    buffer_load_dwordx4 a[0:3], v36, s[32:35], s57 offen sc1
    v_mfma_f32_32x32x16_bf16 v[80:95], a[192:195], a[20:23], v[80:95]
    v_mfma_f32_32x32x16_bf16 v[96:111], a[196:199], a[16:19], v[96:111]
    buffer_load_dwordx4 a[4:7], v37, s[32:35], s57 offen sc1
    v_mfma_f32_32x32x16_bf16 v[112:127], a[196:199], a[20:23], v[112:127]
    s_waitcnt vmcnt(15)
    v_mfma_f32_32x32x16_bf16 v[64:79], a[200:203], a[24:27], v[64:79]
    buffer_load_dwordx4 a[8:11], v36, s[32:35], s57 offen offset:1024 sc1
    v_mfma_f32_32x32x16_bf16 v[80:95], a[200:203], a[28:31], v[80:95]
    v_mfma_f32_32x32x16_bf16 v[96:111], a[204:207], a[24:27], v[96:111]
    buffer_load_dwordx4 a[12:15], v37, s[32:35], s57 offen offset:1024 sc1
    v_mfma_f32_32x32x16_bf16 v[112:127], a[204:207], a[28:31], v[112:127]
    s_waitcnt vmcnt(15)
    s_waitcnt vmcnt(4)
    v_cmp_ne_u32 vcc, s63, v31
    s_nop 4
    s_cbranch_vccnz L_fs_slow
L_fs_ok:
    v_mfma_f32_32x32x16_bf16 v[64:79], a[208:211], a[32:35], v[64:79]
    buffer_load_dwordx4 a[16:19], v38, s[32:35], s92 offen sc1
    v_mfma_f32_32x32x16_bf16 v[80:95], a[208:211], a[36:39], v[80:95]
    v_mfma_f32_32x32x16_bf16 v[96:111], a[212:215], a[32:35], v[96:111]
    buffer_load_dwordx4 a[20:23], v39, s[32:35], s92 offen sc1
    v_mfma_f32_32x32x16_bf16 v[112:127], a[212:215], a[36:39], v[112:127]
    v_mfma_f32_32x32x16_bf16 v[64:79], a[216:219], a[40:43], v[64:79]
    buffer_load_dwordx4 a[24:27], v38, s[32:35], s92 offen offset:1024 sc1
    v_mfma_f32_32x32x16_bf16 v[80:95], a[216:219], a[44:47], v[80:95]
    v_mfma_f32_32x32x16_bf16 v[96:111], a[220:223], a[40:43], v[96:111]
    buffer_load_dwordx4 a[28:31], v39, s[32:35], s92 offen offset:1024 sc1
    v_mfma_f32_32x32x16_bf16 v[112:127], a[220:223], a[44:47], v[112:127]
    v_mfma_f32_32x32x16_bf16 v[64:79], a[224:227], a[48:51], v[64:79]
    buffer_load_dwordx4 a[32:35], v38, s[32:35], s93 offen sc1
    v_mfma_f32_32x32x16_bf16 v[80:95], a[224:227], a[52:55], v[80:95]
    v_mfma_f32_32x32x16_bf16 v[96:111], a[228:231], a[48:51], v[96:111]
    buffer_load_dwordx4 a[36:39], v39, s[32:35], s93 offen sc1
    v_mfma_f32_32x32x16_bf16 v[112:127], a[228:231], a[52:55], v[112:127]
    v_mfma_f32_32x32x16_bf16 v[64:79], a[232:235], a[56:59], v[64:79]
    buffer_load_dwordx4 a[40:43], v38, s[32:35], s93 offen offset:1024 sc1
    v_mfma_f32_32x32x16_bf16 v[80:95], a[232:235], a[60:63], v[80:95]
    v_mfma_f32_32x32x16_bf16 v[96:111], a[236:239], a[56:59], v[96:111]
    buffer_load_dwordx4 a[44:47], v39, s[32:35], s93 offen offset:1024 sc1
    v_mfma_f32_32x32x16_bf16 v[112:127], a[236:239], a[60:63], v[112:127]
    v_mfma_f32_32x32x16_bf16 v[64:79], a[240:243], a[64:67], v[64:79]
    buffer_load_dwordx4 a[48:51], v38, s[32:35], s94 offen sc1
    v_mfma_f32_32x32x16_bf16 v[80:95], a[240:243], a[68:71], v[80:95]
    v_mfma_f32_32x32x16_bf16 v[96:111], a[244:247], a[64:67], v[96:111]
    buffer_load_dwordx4 a[52:55], v39, s[32:35], s94 offen sc1
    v_mfma_f32_32x32x16_bf16 v[112:127], a[244:247], a[68:71], v[112:127]
    v_mfma_f32_32x32x16_bf16 v[64:79], a[248:251], a[72:75], v[64:79]
    buffer_load_dwordx4 a[56:59], v38, s[32:35], s94 offen offset:1024 sc1
    v_mfma_f32_32x32x16_bf16 v[80:95], a[248:251], a[76:79], v[80:95]
    v_mfma_f32_32x32x16_bf16 v[96:111], a[252:255], a[72:75], v[96:111]
    buffer_load_dwordx4 a[60:63], v39, s[32:35], s94 offen offset:1024 sc1
    v_mfma_f32_32x32x16_bf16 v[112:127], a[252:255], a[76:79], v[112:127]
    s_waitcnt vmcnt(14)
    v_mfma_f32_32x32x16_bf16 v[64:79], a[0:3], a[80:83], v[64:79]
    buffer_load_dwordx4 a[64:67], v38, s[32:35], s95 offen sc1
    v_mfma_f32_32x32x16_bf16 v[80:95], a[0:3], a[84:87], v[80:95]
    s_mov_b32 s101, 0
    buffer_load_dwordx2 a[240:241], v26, s[4:7], s101 offen
    v_mfma_f32_32x32x16_bf16 v[96:111], a[4:7], a[80:83], v[96:111]
    buffer_load_dwordx4 a[68:71], v39, s[32:35], s95 offen sc1
    v_mfma_f32_32x32x16_bf16 v[112:127], a[4:7], a[84:87], v[112:127]
    s_mov_b32 s101, 4096
    buffer_load_dwordx2 a[242:243], v26, s[4:7], s101 offen
    s_waitcnt vmcnt(16)
    v_mfma_f32_32x32x16_bf16 v[64:79], a[8:11], a[88:91], v[64:79]
    buffer_load_dwordx4 a[72:75], v38, s[32:35], s95 offen offset:1024 sc1
    v_mfma_f32_32x32x16_bf16 v[80:95], a[8:11], a[92:95], v[80:95]
    ds_read_b128 v[192:195], v18 offset:0
    ds_read_b128 v[196:199], v18 offset:8192
    s_mov_b32 s101, 8192
    buffer_load_dwordx2 a[244:245], v26, s[4:7], s101 offen
    v_mfma_f32_32x32x16_bf16 v[96:111], a[12:15], a[88:91], v[96:111]
    buffer_load_dwordx4 a[76:79], v39, s[32:35], s95 offen offset:1024 sc1
    v_mfma_f32_32x32x16_bf16 v[112:127], a[12:15], a[92:95], v[112:127]
    s_mov_b32 s101, 12288
    buffer_load_dwordx2 a[246:247], v26, s[4:7], s101 offen
    s_waitcnt vmcnt(18)
    s_waitcnt lgkmcnt(0)
    v_mfma_f32_32x32x16_bf16 v[128:143], a[16:19], v[192:195], 0
    buffer_load_dwordx4 a[80:83], v38, s[32:35], s92 offen offset:2048 sc1
    v_mfma_f32_32x32x16_bf16 v[144:159], a[16:19], v[196:199], 0
    ds_read_b128 v[200:203], v19 offset:0
    ds_read_b128 v[204:207], v19 offset:8192
    v_mfma_f32_32x32x16_bf16 v[160:175], a[20:23], v[192:195], 0
    buffer_load_dwordx4 a[84:87], v39, s[32:35], s92 offen offset:2048 sc1
    v_lshlrev_b32 v30, 6, v51
    v_add_u32 v30, 153600, v30
    v_mfma_f32_32x32x16_bf16 v[176:191], a[20:23], v[196:199], 0
    s_lshl_b32 s85, s60, 6
    s_add_u32 s85, s85, 153600
    v_mov_b32_e64 v31, s85
    s_waitcnt vmcnt(18)
    s_waitcnt lgkmcnt(0)
    v_mfma_f32_32x32x16_bf16 v[128:143], a[24:27], v[200:203], v[128:143]
    buffer_load_dwordx4 a[88:91], v38, s[32:35], s92 offen offset:3072 sc1
    ds_read_b128 v[208:211], v30 offset:256
    v_mfma_f32_32x32x16_bf16 v[144:159], a[24:27], v[204:207], v[144:159]
    ds_read_b128 v[192:195], v20 offset:0
    ds_read_b128 v[196:199], v20 offset:8192
    ds_read_b128 v[212:215], v30 offset:272
    ds_read_b128 v[216:219], v30 offset:288
    v_mfma_f32_32x32x16_bf16 v[160:175], a[28:31], v[200:203], v[160:175]
    buffer_load_dwordx4 a[92:95], v39, s[32:35], s92 offen offset:3072 sc1
    ds_read_b128 v[220:223], v30 offset:304
    ds_read_b128 v[224:227], v30 offset:384
    v_mfma_f32_32x32x16_bf16 v[176:191], a[28:31], v[204:207], v[176:191]
    ds_read_b128 v[228:231], v30 offset:400
    ds_read_b128 v[232:235], v30 offset:416
    s_waitcnt vmcnt(18)
    s_waitcnt lgkmcnt(6)
    v_mfma_f32_32x32x16_bf16 v[128:143], a[32:35], v[192:195], v[128:143]
    buffer_load_dwordx4 a[96:99], v38, s[32:35], s93 offen offset:2048 sc1
    ds_read_b128 v[236:239], v30 offset:432
    v_mfma_f32_32x32x16_bf16 v[144:159], a[32:35], v[196:199], v[144:159]
    ds_read_b128 v[200:203], v21 offset:0
    ds_read_b128 v[204:207], v21 offset:8192
    v_mfma_f32_32x32x16_bf16 v[160:175], a[36:39], v[192:195], v[160:175]
    buffer_load_dwordx4 a[100:103], v39, s[32:35], s93 offen offset:2048 sc1
    v_mfma_f32_32x32x16_bf16 v[176:191], a[36:39], v[196:199], v[176:191]
    s_waitcnt vmcnt(18)
    s_waitcnt lgkmcnt(0)
    v_mfma_f32_32x32x16_bf16 v[128:143], a[40:43], v[200:203], v[128:143]
    buffer_load_dwordx4 a[104:107], v38, s[32:35], s93 offen offset:3072 sc1
    v_mul_f32 v64, v208, v64
    v_mul_f32 v65, v209, v65
    v_mul_f32 v66, v210, v66
    v_mfma_f32_32x32x16_bf16 v[144:159], a[40:43], v[204:207], v[144:159]
    ds_read_b128 v[192:195], v22 offset:0
    ds_read_b128 v[196:199], v22 offset:8192
    v_mul_f32 v67, v211, v67
    v_mul_f32 v68, v212, v68
    v_mul_f32 v69, v213, v69
    v_mfma_f32_32x32x16_bf16 v[160:175], a[44:47], v[200:203], v[160:175]
    buffer_load_dwordx4 a[108:111], v39, s[32:35], s93 offen offset:3072 sc1
    v_mul_f32 v70, v214, v70
    v_mul_f32 v71, v215, v71
    v_mul_f32 v72, v216, v72
    v_mfma_f32_32x32x16_bf16 v[176:191], a[44:47], v[204:207], v[176:191]
    v_mul_f32 v73, v217, v73
    v_mul_f32 v74, v218, v74
    v_mul_f32 v75, v219, v75
    s_waitcnt vmcnt(18)
    s_waitcnt lgkmcnt(0)
    v_mfma_f32_32x32x16_bf16 v[128:143], a[48:51], v[192:195], v[128:143]
    buffer_load_dwordx4 a[112:115], v38, s[32:35], s94 offen offset:2048 sc1
    v_mul_f32 v76, v220, v76
    v_mul_f32 v77, v221, v77
    v_mul_f32_e64 v78, v222, v78
    v_mfma_f32_32x32x16_bf16 v[144:159], a[48:51], v[196:199], v[144:159]
    ds_read_b128 v[200:203], v23 offset:0
    ds_read_b128 v[204:207], v23 offset:8192
    v_mul_f32 v79, v223, v79
    v_mul_f32 v80, v208, v80
    v_mul_f32 v81, v209, v81
    v_mfma_f32_32x32x16_bf16 v[160:175], a[52:55], v[192:195], v[160:175]
    buffer_load_dwordx4 a[116:119], v39, s[32:35], s94 offen offset:2048 sc1
    v_mul_f32 v82, v210, v82
    v_mul_f32 v83, v211, v83
    v_mul_f32 v84, v212, v84
    v_mfma_f32_32x32x16_bf16 v[176:191], a[52:55], v[196:199], v[176:191]
    v_mul_f32 v85, v213, v85
    v_mul_f32 v86, v214, v86
    v_mul_f32_e64 v87, v215, v87
    s_waitcnt vmcnt(18)
    s_waitcnt lgkmcnt(0)
    v_mfma_f32_32x32x16_bf16 v[128:143], a[56:59], v[200:203], v[128:143]
    buffer_load_dwordx4 a[120:123], v38, s[32:35], s94 offen offset:3072 sc1
    v_mul_f32 v88, v216, v88
    v_mul_f32 v89, v217, v89
    v_mul_f32_e64 v90, v218, v90
    v_mfma_f32_32x32x16_bf16 v[144:159], a[56:59], v[204:207], v[144:159]
    ds_read_b128 v[192:195], v24 offset:0
    ds_read_b128 v[196:199], v24 offset:8192
    v_mul_f32 v91, v219, v91
    v_mul_f32 v92, v220, v92
    v_mul_f32 v93, v221, v93
    v_mfma_f32_32x32x16_bf16 v[160:175], a[60:63], v[200:203], v[160:175]
    buffer_load_dwordx4 a[124:127], v39, s[32:35], s94 offen offset:3072 sc1
    v_mul_f32 v94, v222, v94
    v_mul_f32 v95, v223, v95
    v_mul_f32 v96, v224, v96
    v_mfma_f32_32x32x16_bf16 v[176:191], a[60:63], v[204:207], v[176:191]
    v_mul_f32 v97, v225, v97
    v_mul_f32 v98, v226, v98
    v_mul_f32_e64 v99, v227, v99
    s_waitcnt vmcnt(17)
    s_waitcnt lgkmcnt(0)
    v_mfma_f32_32x32x16_bf16 v[128:143], a[64:67], v[192:195], v[128:143]
    buffer_load_dwordx4 a[128:131], v38, s[32:35], s95 offen offset:2048 sc1
    v_mul_f32 v100, v228, v100
    v_mul_f32 v101, v229, v101
    v_mul_f32_e64 v102, v230, v102
    v_mfma_f32_32x32x16_bf16 v[144:159], a[64:67], v[196:199], v[144:159]
    ds_read_b128 v[200:203], v25 offset:0
    ds_read_b128 v[204:207], v25 offset:8192
    v_mul_f32 v103, v231, v103
    v_mul_f32 v104, v232, v104
    v_mul_f32 v105, v233, v105
    v_mfma_f32_32x32x16_bf16 v[160:175], a[68:71], v[192:195], v[160:175]
    buffer_load_dwordx4 a[132:135], v39, s[32:35], s95 offen offset:2048 sc1
    v_mul_f32 v106, v234, v106
    v_mul_f32 v107, v235, v107
    v_mul_f32 v108, v236, v108
    v_mfma_f32_32x32x16_bf16 v[176:191], a[68:71], v[196:199], v[176:191]
    v_mul_f32 v109, v237, v109
    v_mul_f32 v110, v238, v110
    v_mul_f32_e64 v111, v239, v111
    s_waitcnt vmcnt(15)
    s_waitcnt lgkmcnt(0)
    v_mfma_f32_32x32x16_bf16 v[128:143], a[72:75], v[200:203], v[128:143]
    buffer_load_dwordx4 a[136:139], v38, s[32:35], s95 offen offset:3072 sc1
    v_mul_f32 v112, v224, v112
    v_mul_f32 v113, v225, v113
    v_mul_f32_e64 v114, v226, v114
    v_mfma_f32_32x32x16_bf16 v[144:159], a[72:75], v[204:207], v[144:159]
    ds_read_b128 v[192:195], v18 offset:16384
    ds_read_b128 v[196:199], v18 offset:24576
    v_mul_f32 v115, v227, v115
    v_mul_f32 v116, v228, v116
    v_mul_f32 v117, v229, v117
    v_mfma_f32_32x32x16_bf16 v[160:175], a[76:79], v[200:203], v[160:175]
    buffer_load_dwordx4 a[140:143], v39, s[32:35], s95 offen offset:3072 sc1
    v_mul_f32 v118, v230, v118
    v_mul_f32 v119, v231, v119
    v_mul_f32 v120, v232, v120
    v_mfma_f32_32x32x16_bf16 v[176:191], a[76:79], v[204:207], v[176:191]
    v_mul_f32 v121, v233, v121
    v_mul_f32 v122, v234, v122
    v_mul_f32_e64 v123, v235, v123
    s_waitcnt vmcnt(14)
    s_waitcnt lgkmcnt(0)
    v_mfma_f32_32x32x16_bf16 v[128:143], a[80:83], v[192:195], v[128:143]
    v_mul_f32 v124, v236, v124
    v_mul_f32 v125, v237, v125
    v_mul_f32_e64 v126, v238, v126
    v_mfma_f32_32x32x16_bf16 v[144:159], a[80:83], v[196:199], v[144:159]
    ds_read_b128 v[200:203], v19 offset:16384
    ds_read_b128 v[204:207], v19 offset:24576
    v_mul_f32 v127, v239, v127
    v_mfma_f32_32x32x16_bf16 v[160:175], a[84:87], v[192:195], v[160:175]
    v_lshrrev_b32 v27, 4, v1
    v_lshlrev_b32 v27, 2, v27
    v_add_u32 v31, v31, v27
    ds_read_b32 v208, v31 offset:0
    v_mfma_f32_32x32x16_bf16 v[176:191], a[84:87], v[196:199], v[176:191]
    ds_read_b32 v212, v31 offset:256
    ds_read_b32 v209, v31 offset:16
    ds_read_b32 v213, v31 offset:272
    ds_read_b32 v210, v31 offset:32
    ds_read_b32 v214, v31 offset:288
    s_waitcnt vmcnt(12)
    s_waitcnt lgkmcnt(6)
    v_mfma_f32_32x32x16_bf16 v[128:143], a[88:91], v[200:203], v[128:143]
    ds_read_b32 v211, v31 offset:48
    ds_read_b32 v215, v31 offset:304
    v_lshlrev_b32_e64 v216, 16, v40
    v_and_b32 v217, 0xffff0000, v40
    v_mfma_f32_32x32x16_bf16 v[144:159], a[88:91], v[204:207], v[144:159]
    ds_read_b128 v[192:195], v20 offset:16384
    ds_read_b128 v[196:199], v20 offset:24576
    v_lshlrev_b32 v220, 16, v42
    v_and_b32 v221, 0xffff0000, v42
    v_lshlrev_b32 v218, 16, v41
    v_and_b32 v219, 0xffff0000, v41
    v_lshlrev_b32 v222, 16, v43
    v_mfma_f32_32x32x16_bf16 v[160:175], a[92:95], v[200:203], v[160:175]
    v_and_b32 v223, 0xffff0000, v43
    s_waitcnt lgkmcnt(2)
    v_accvgpr_read_b32 v27, a240
    v_mul_f32 v240, v212, v220
    v_mul_f32 v241, v212, v221
    v_mfma_f32_32x32x16_bf16 v[176:191], a[92:95], v[204:207], v[176:191]
    v_lshlrev_b32 v28, 16, v27
    v_and_b32 v27, 0xffff0000, v27
    v_mul_f32 v28, v28, v216
    v_mul_f32 v27, v27, v217
    v_fmac_f32 v240, v208, v28
    s_waitcnt vmcnt(10)
    s_waitcnt lgkmcnt(0)
    v_mfma_f32_32x32x16_bf16 v[128:143], a[96:99], v[192:195], v[128:143]
    v_fmac_f32_e64 v241, v208, v27
    v_accvgpr_read_b32 v27, a241
    v_mul_f32 v242, v212, v222
    v_mul_f32 v243, v212, v223
    v_mfma_f32_32x32x16_bf16 v[144:159], a[96:99], v[196:199], v[144:159]
    ds_read_b128 v[200:203], v21 offset:16384
    ds_read_b128 v[204:207], v21 offset:24576
    v_lshlrev_b32 v28, 16, v27
    v_and_b32 v27, 0xffff0000, v27
    v_mul_f32 v28, v28, v218
    v_mul_f32 v27, v27, v219
    v_fmac_f32 v242, v208, v28
    v_mfma_f32_32x32x16_bf16 v[160:175], a[100:103], v[192:195], v[160:175]
    v_fmac_f32 v243, v208, v27
    v_accvgpr_read_b32 v27, a242
    v_mul_f32 v244, v213, v220
    v_mul_f32_e64 v245, v213, v221
    v_mfma_f32_32x32x16_bf16 v[176:191], a[100:103], v[196:199], v[176:191]
    v_lshlrev_b32 v28, 16, v27
    v_and_b32 v27, 0xffff0000, v27
    v_mul_f32 v28, v28, v216
    v_mul_f32 v27, v27, v217
    v_fmac_f32 v244, v209, v28
    s_waitcnt vmcnt(8)
    s_waitcnt lgkmcnt(0)
    v_mfma_f32_32x32x16_bf16 v[128:143], a[104:107], v[200:203], v[128:143]
    v_fmac_f32 v245, v209, v27
    v_accvgpr_read_b32 v27, a243
    v_mul_f32 v246, v213, v222
    v_mul_f32 v247, v213, v223
    v_mfma_f32_32x32x16_bf16 v[144:159], a[104:107], v[204:207], v[144:159]
    ds_read_b128 v[192:195], v22 offset:16384
    ds_read_b128 v[196:199], v22 offset:24576
    v_lshlrev_b32 v28, 16, v27
    v_and_b32 v27, 0xffff0000, v27
    v_mul_f32 v28, v28, v218
    v_mul_f32 v27, v27, v219
    v_fmac_f32 v246, v209, v28
    v_mfma_f32_32x32x16_bf16 v[160:175], a[108:111], v[200:203], v[160:175]
    v_fmac_f32 v247, v209, v27
    v_accvgpr_read_b32 v27, a244
    v_mul_f32 v248, v214, v220
    v_mul_f32 v249, v214, v221
    v_mfma_f32_32x32x16_bf16 v[176:191], a[108:111], v[204:207], v[176:191]
    v_lshlrev_b32_e64 v28, 16, v27
    v_and_b32 v27, 0xffff0000, v27
    v_mul_f32 v28, v28, v216
    v_mul_f32 v27, v27, v217
    v_fmac_f32_e64 v248, v210, v28
    s_waitcnt vmcnt(6)
    s_waitcnt lgkmcnt(0)
    v_mfma_f32_32x32x16_bf16 v[128:143], a[112:115], v[192:195], v[128:143]
    v_fmac_f32 v249, v210, v27
    v_accvgpr_read_b32 v27, a245
    v_mul_f32 v250, v214, v222
    v_mul_f32_e64 v251, v214, v223
    v_mfma_f32_32x32x16_bf16 v[144:159], a[112:115], v[196:199], v[144:159]
    ds_read_b128 v[200:203], v23 offset:16384
    ds_read_b128 v[204:207], v23 offset:24576
    v_lshlrev_b32_e64 v28, 16, v27
    v_and_b32 v27, 0xffff0000, v27
    v_mul_f32 v28, v28, v218
    v_mul_f32 v27, v27, v219
    v_fmac_f32 v250, v210, v28
    v_mfma_f32_32x32x16_bf16 v[160:175], a[116:119], v[192:195], v[160:175]
    v_fmac_f32 v251, v210, v27
    v_accvgpr_read_b32 v27, a246
    v_mul_f32 v252, v215, v220
    v_mul_f32 v253, v215, v221
    v_mfma_f32_32x32x16_bf16 v[176:191], a[116:119], v[196:199], v[176:191]
    v_lshlrev_b32_e64 v28, 16, v27
    v_and_b32 v27, 0xffff0000, v27
    v_mul_f32 v28, v28, v216
    v_mul_f32 v27, v27, v217
    v_fmac_f32_e64 v252, v211, v28
    s_waitcnt vmcnt(4)
    s_waitcnt lgkmcnt(0)
    v_mfma_f32_32x32x16_bf16 v[128:143], a[120:123], v[200:203], v[128:143]
    v_fmac_f32 v253, v211, v27
    v_accvgpr_read_b32 v27, a247
    v_mul_f32 v254, v215, v222
    v_mul_f32_e64 v255, v215, v223
    v_mfma_f32_32x32x16_bf16 v[144:159], a[120:123], v[204:207], v[144:159]
    ds_read_b128 v[192:195], v24 offset:16384
    ds_read_b128 v[196:199], v24 offset:24576
    v_lshlrev_b32_e64 v28, 16, v27
    v_and_b32 v27, 0xffff0000, v27
    v_mul_f32 v28, v28, v218
    v_mul_f32 v27, v27, v219
    v_fmac_f32 v254, v211, v28
    v_mfma_f32_32x32x16_bf16 v[160:175], a[124:127], v[200:203], v[160:175]
    v_fmac_f32 v255, v211, v27
    v_mfma_f32_32x32x16_bf16 v[176:191], a[124:127], v[204:207], v[176:191]
    ds_read_b128 v[208:211], v30 offset:0
    ds_read_b128 v[212:215], v30 offset:16
    ds_read_b128 v[216:219], v30 offset:32
    s_waitcnt vmcnt(2)
    s_waitcnt lgkmcnt(3)
    v_mfma_f32_32x32x16_bf16 v[128:143], a[128:131], v[192:195], v[128:143]
    ds_read_b128 v[220:223], v30 offset:48
    ds_read_b128 v[224:227], v30 offset:128
    ds_read_b128 v[228:231], v30 offset:144
    v_mfma_f32_32x32x16_bf16 v[144:159], a[128:131], v[196:199], v[144:159]
    ds_read_b128 v[200:203], v25 offset:16384
    ds_read_b128 v[204:207], v25 offset:24576
    ds_read_b128 v[232:235], v30 offset:160
    ds_read_b128 v[236:239], v30 offset:176
    v_lshlrev_b32_e64 v31, 12, v51
    v_mfma_f32_32x32x16_bf16 v[160:175], a[132:135], v[192:195], v[160:175]
    v_lshl_add_u32 v31, v50, 2, v31
    v_add_u32 v31, s65, v31
    v_add_u32 v28, 128, v31
    v_mfma_f32_32x32x16_bf16 v[176:191], a[132:135], v[196:199], v[176:191]
    v_lshrrev_b32 v27, 4, v1
    v_lshlrev_b32 v32, 8, v27
    v_and_b32 v29, 15, v1
    s_waitcnt vmcnt(0)
    s_waitcnt lgkmcnt(2)
    v_mfma_f32_32x32x16_bf16 v[128:143], a[136:139], v[200:203], v[128:143]
    v_lshl_add_u32 v32, v29, 4, v32
    s_lshl_b32 s85, s60, 12
    v_add_u32 v32, s85, v32
    v_mfma_f32_32x32x16_bf16 v[144:159], a[136:139], v[204:207], v[144:159]
    v_add_u32 v33, 36864, v32
    v_add_u32 v34, 73728, v32
    v_add_u32 v35, 110592, v32
    v_mfma_f32_32x32x16_bf16 v[160:175], a[140:143], v[200:203], v[160:175]
    s_lshl_b32 s72, s61, 6
    s_lshl_b32 s73, s60, 4
    s_add_u32 s72, s72, s73
    v_add_u32 v26, s72, v27
    s_lshl_b32 s73, s62, 8
    v_lshlrev_b32 v26, 11, v26
    v_lshl_add_u32 v26, v29, 4, v26
    v_add_u32_e64 v26, s73, v26
    v_mfma_f32_32x32x16_bf16 v[176:191], a[140:143], v[204:207], v[176:191]
    v_pk_fma_f32 v[64:65], v[208:209], v[128:129], v[64:65]
    v_pk_fma_f32 v[66:67], v[210:211], v[130:131], v[66:67]
    ds_write2st64_b32 v31, v64, v65 offset0:0 offset1:1
    v_pk_fma_f32 v[68:69], v[212:213], v[132:133], v[68:69]
    ds_write2st64_b32 v31, v66, v67 offset0:2 offset1:3
    v_pk_fma_f32 v[70:71], v[214:215], v[134:135], v[70:71]
    ds_write2st64_b32 v31, v68, v69 offset0:4 offset1:5
    v_pk_fma_f32 v[72:73], v[216:217], v[136:137], v[72:73]
    ds_write2st64_b32 v31, v70, v71 offset0:6 offset1:7
    v_pk_fma_f32 v[74:75], v[218:219], v[138:139], v[74:75]
    ds_write2st64_b32 v31, v72, v73 offset0:8 offset1:9
    v_pk_fma_f32 v[76:77], v[220:221], v[140:141], v[76:77]
    ds_write2st64_b32 v31, v74, v75 offset0:10 offset1:11
    v_pk_fma_f32 v[78:79], v[222:223], v[142:143], v[78:79]
    ds_write2st64_b32 v31, v76, v77 offset0:12 offset1:13
    ds_write2st64_b32 v31, v78, v79 offset0:14 offset1:15
    v_pk_fma_f32 v[80:81], v[208:209], v[144:145], v[80:81]
    v_pk_fma_f32 v[82:83], v[210:211], v[146:147], v[82:83]
    ds_write2st64_b32 v28, v80, v81 offset0:0 offset1:1
    v_pk_fma_f32 v[84:85], v[212:213], v[148:149], v[84:85]
    ds_write2st64_b32 v28, v82, v83 offset0:2 offset1:3
    v_pk_fma_f32 v[86:87], v[214:215], v[150:151], v[86:87]
    ds_write2st64_b32 v28, v84, v85 offset0:4 offset1:5
    v_pk_fma_f32 v[88:89], v[216:217], v[152:153], v[88:89]
    ds_write2st64_b32 v28, v86, v87 offset0:6 offset1:7
    v_pk_fma_f32 v[90:91], v[218:219], v[154:155], v[90:91]
    ds_write2st64_b32 v28, v88, v89 offset0:8 offset1:9
    v_pk_fma_f32 v[92:93], v[220:221], v[156:157], v[92:93]
    ds_write2st64_b32 v28, v90, v91 offset0:10 offset1:11
    v_pk_fma_f32 v[94:95], v[222:223], v[158:159], v[94:95]
    ds_write2st64_b32 v28, v92, v93 offset0:12 offset1:13
    ds_write2st64_b32 v28, v94, v95 offset0:14 offset1:15
    s_waitcnt lgkmcnt(14)
    v_pk_fma_f32 v[96:97], v[224:225], v[160:161], v[96:97]
    v_pk_fma_f32 v[98:99], v[226:227], v[162:163], v[98:99]
    ds_write2st64_b32 v31, v96, v97 offset0:32 offset1:33
    v_pk_fma_f32 v[100:101], v[228:229], v[164:165], v[100:101]
    ds_write2st64_b32 v31, v98, v99 offset0:34 offset1:35
    v_pk_fma_f32 v[102:103], v[230:231], v[166:167], v[102:103]
    ds_write2st64_b32 v31, v100, v101 offset0:36 offset1:37
    v_pk_fma_f32 v[104:105], v[232:233], v[168:169], v[104:105]
    ds_write2st64_b32 v31, v102, v103 offset0:38 offset1:39
    v_pk_fma_f32 v[106:107], v[234:235], v[170:171], v[106:107]
    ds_write2st64_b32 v31, v104, v105 offset0:40 offset1:41
    v_pk_fma_f32 v[108:109], v[236:237], v[172:173], v[108:109]
    ds_write2st64_b32 v31, v106, v107 offset0:42 offset1:43
    v_pk_fma_f32 v[110:111], v[238:239], v[174:175], v[110:111]
    ds_write2st64_b32 v31, v108, v109 offset0:44 offset1:45
    ds_write2st64_b32 v31, v110, v111 offset0:46 offset1:47
    v_pk_fma_f32 v[112:113], v[224:225], v[176:177], v[112:113]
    v_pk_fma_f32 v[114:115], v[226:227], v[178:179], v[114:115]
    ds_write2st64_b32 v28, v112, v113 offset0:32 offset1:33
    v_pk_fma_f32 v[116:117], v[228:229], v[180:181], v[116:117]
    ds_write2st64_b32 v28, v114, v115 offset0:34 offset1:35
    v_pk_fma_f32 v[118:119], v[230:231], v[182:183], v[118:119]
    ds_write2st64_b32 v28, v116, v117 offset0:36 offset1:37
    v_pk_fma_f32 v[120:121], v[232:233], v[184:185], v[120:121]
    ds_write2st64_b32 v28, v118, v119 offset0:38 offset1:39
    v_pk_fma_f32 v[122:123], v[234:235], v[186:187], v[122:123]
    ds_write2st64_b32 v28, v120, v121 offset0:40 offset1:41
    v_pk_fma_f32 v[124:125], v[236:237], v[188:189], v[124:125]
    ds_write2st64_b32 v28, v122, v123 offset0:42 offset1:43
    v_pk_fma_f32 v[126:127], v[238:239], v[190:191], v[126:127]
    ds_write2st64_b32 v28, v124, v125 offset0:44 offset1:45
    ds_write2st64_b32 v28, v126, v127 offset0:46 offset1:47
    s_waitcnt lgkmcnt(0)
    s_barrier
    ds_read_b128 v[64:67], v32 offset:0
    ds_read_b128 v[80:83], v33 offset:0
    ds_read_b128 v[96:99], v34 offset:0
    ds_read_b128 v[112:115], v35 offset:0
    ds_read_b128 v[68:71], v32 offset:1024
    ds_read_b128 v[84:87], v33 offset:1024
    ds_read_b128 v[100:103], v34 offset:1024
    ds_read_b128 v[116:119], v35 offset:1024
    ds_read_b128 v[72:75], v32 offset:2048
    ds_read_b128 v[88:91], v33 offset:2048
    ds_read_b128 v[104:107], v34 offset:2048
    ds_read_b128 v[120:123], v35 offset:2048
    ds_read_b128 v[76:79], v32 offset:3072
    ds_read_b128 v[92:95], v33 offset:3072
    ds_read_b128 v[108:111], v34 offset:3072
    ds_read_b128 v[124:127], v35 offset:3072
    s_waitcnt lgkmcnt(12)
    v_pk_add_f32 v[64:65], v[64:65], v[80:81]
    v_pk_add_f32 v[96:97], v[96:97], v[112:113]
    v_pk_add_f32 v[64:65], v[64:65], v[240:241]
    v_pk_add_f32 v[66:67], v[66:67], v[82:83]
    v_pk_add_f32 v[98:99], v[98:99], v[114:115]
    v_pk_add_f32 v[66:67], v[66:67], v[242:243]
    v_pk_add_f32 v[64:65], v[64:65], v[96:97]
    v_pk_add_f32 v[66:67], v[66:67], v[98:99]
    s_mov_b32 s72, 0
    buffer_store_dwordx4 v[64:67], v26, s[36:39], s72 offen sc1
    s_waitcnt lgkmcnt(8)
    v_pk_add_f32 v[68:69], v[68:69], v[84:85]
    v_pk_add_f32 v[100:101], v[100:101], v[116:117]
    v_pk_add_f32 v[68:69], v[68:69], v[244:245]
    v_pk_add_f32 v[70:71], v[70:71], v[86:87]
    v_pk_add_f32 v[102:103], v[102:103], v[118:119]
    v_pk_add_f32 v[70:71], v[70:71], v[246:247]
    v_pk_add_f32 v[68:69], v[68:69], v[100:101]
    v_pk_add_f32 v[70:71], v[70:71], v[102:103]
    s_mov_b32 s72, 8192
    buffer_store_dwordx4 v[68:71], v26, s[36:39], s72 offen sc1
    s_waitcnt lgkmcnt(4)
    v_pk_add_f32 v[72:73], v[72:73], v[88:89]
    v_pk_add_f32 v[104:105], v[104:105], v[120:121]
    v_pk_add_f32 v[72:73], v[72:73], v[248:249]
    v_pk_add_f32 v[74:75], v[74:75], v[90:91]
    v_pk_add_f32 v[106:107], v[106:107], v[122:123]
    v_pk_add_f32 v[74:75], v[74:75], v[250:251]
    v_pk_add_f32 v[72:73], v[72:73], v[104:105]
    v_pk_add_f32 v[74:75], v[74:75], v[106:107]
    s_mov_b32 s72, 16384
    buffer_store_dwordx4 v[72:75], v26, s[36:39], s72 offen sc1
    s_waitcnt lgkmcnt(0)
    v_pk_add_f32 v[76:77], v[76:77], v[92:93]
    v_pk_add_f32 v[108:109], v[108:109], v[124:125]
    v_pk_add_f32 v[76:77], v[76:77], v[252:253]
    v_pk_add_f32 v[78:79], v[78:79], v[94:95]
    v_pk_add_f32 v[110:111], v[110:111], v[126:127]
    v_pk_add_f32 v[78:79], v[78:79], v[254:255]
    v_pk_add_f32 v[76:77], v[76:77], v[108:109]
    v_pk_add_f32 v[78:79], v[78:79], v[110:111]
    s_mov_b32 s72, 24576
    buffer_store_dwordx4 v[76:79], v26, s[36:39], s72 offen sc1
L_end:
    s_endpgm
L_nonce_slow:
    s_mov_b32 s85, 0
L_nonce_loop:
    buffer_load_dword v49, off, s[40:43], 0 sc0 sc1
    s_waitcnt vmcnt(0)
    v_cmp_ne_u32 vcc, 0, v49
    s_add_u32 s85, s85, 1
    s_cmp_gt_u32 s85, 400000
    s_cbranch_scc1 L_nonce_ok
    s_nop 2
    s_cbranch_vccz L_nonce_loop
    s_branch L_nonce_ok
L_e_slow:
    s_mov_b32 s85, 0
L_e_loop:
    s_mov_b64 exec, s[74:75]
    buffer_load_dwordx4 v[224:227], v232, s[32:35], s87 offen sc1
    s_mov_b64 exec, s[76:77]
    buffer_load_dwordx4 v[228:231], v233, s[32:35], s87 offen sc1
    s_mov_b64 exec, -1
    s_waitcnt vmcnt(0)
    s_mov_b64 exec, s[74:75]
    v_cmp_ne_u32 s[78:79], v49, v225
    v_cmp_ne_u32 s[80:81], v49, v227
    s_nop 3
    s_or_b64 s[78:79], s[78:79], s[80:81]
    s_mov_b64 exec, s[76:77]
    v_cmp_ne_u32 vcc, v49, v229
    v_cmp_ne_u32 s[80:81], v49, v231
    s_nop 3
    s_or_b64 s[78:79], s[78:79], vcc
    s_mov_b64 exec, -1
    s_or_b64 s[78:79], s[78:79], s[80:81]
    s_cbranch_scc0 L_eok
    s_add_u32 s85, s85, 1
    s_cmp_le_u32 s85, 400000
    s_cbranch_scc1 L_e_loop
    s_branch L_eok
L_f_slow:
    s_mov_b32 s85, 0
L_fpoll:
    buffer_load_dword v31, v30, s[32:35], s87 offen sc1
    s_waitcnt vmcnt(0)
    v_cmp_ne_u32 vcc, s63, v31
    s_add_u32 s85, s85, 1
    s_cmp_gt_u32 s85, 400000
    s_cbranch_scc1 L_fok
    s_nop 2
    s_cbranch_vccnz L_fpoll
    s_branch L_fok
L_fs_slow:
    s_mov_b32 s85, 0
L_fs_loop:
    buffer_load_dword v31, v30, s[32:35], s87 offen offset:2048 sc1
    s_waitcnt vmcnt(0)
    v_cmp_ne_u32 vcc, s63, v31
    s_add_u32 s85, s85, 1
    s_cmp_gt_u32 s85, 400000
    s_cbranch_scc1 L_fs_ok
    s_nop 2
    s_cbranch_vccnz L_fs_loop
    s_branch L_fs_ok

    .fill 9216, 4, 0xbf800000
.section .rodata,"a"
.p2align 6
.amdhsa_kernel gated_mix__ssm_conv_s5__dense_activation_squared_relu__prompt_kernel
  .amdhsa_next_free_vgpr 512
  .amdhsa_next_free_sgpr 102
  .amdhsa_accum_offset 256
  .amdhsa_group_segment_fixed_size 0
  .amdhsa_kernarg_size 144
  .amdhsa_user_sgpr_count 2
  .amdhsa_user_sgpr_kernarg_segment_ptr 1
  .amdhsa_system_sgpr_workgroup_id_x 1
  .amdhsa_float_denorm_mode_32 3
.end_amdhsa_kernel
```
